```python
import torch

def _softmax(x, axis=-1):
    return torch.softmax(x, dim=axis)
def _gelu(x):
    return torch.nn.functional.gelu(x, approximate="tanh")
def _silu(x):
    return torch.nn.functional.silu(x)
def _sigmoid(x):
    return torch.sigmoid(x)
def _layernorm(x, axis=-1, eps=1e-5):
    m = x.mean(dim=axis, keepdim=True)
    v = x.var(dim=axis, keepdim=True, unbiased=False)
    return (x - m) / torch.sqrt(v + eps)
def _scatter_add(tgt, idx, src, axis=0):
    return tgt.clone().index_add_(axis, idx, src)
def _segment_sum(src, seg, n):
    out = torch.zeros((n,) + src.shape[1:], dtype=src.dtype)
    return out.index_add_(0, seg, src)
def _pad(x, pw):
    flat = tuple(v for pair in reversed(pw) for v in pair)
    return torch.nn.functional.pad(x, flat)

kernel_name = 'sequential_preLN__softmax_full_mha__dense_activation_relu__prompt'

def setup_inputs():

    _w = (lambda a: (lambda t: t.to(torch.bfloat16) if t.is_floating_point() else t)(torch.as_tensor(a)))
    def _A_setup():
        B, S, D = 1, 2048, 512
        return {
            "x": _w((lambda *s: torch.randn(*s, dtype=torch.bfloat16) * 0.05)(B, S, D)),
            "wqkv": _w((lambda *s: torch.randn(*s, dtype=torch.bfloat16) * 0.05)(D, 3 * D)),
            "wo": _w((lambda *s: torch.randn(*s, dtype=torch.bfloat16) * 0.05)(D, D)),
        }
    _A_in = _A_setup()

    def _B_setup():
        B, S, D, Dff = 1, 2048, 512, 1792
        return {
            "x": _w((lambda *s: torch.randn(*s, dtype=torch.bfloat16) * 0.05)(B, S, D)),
            "w1": _w((lambda *s: torch.randn(*s, dtype=torch.bfloat16) * 0.05)(D, Dff)),
            "w2": _w((lambda *s: torch.randn(*s, dtype=torch.bfloat16) * 0.05)(Dff, D)),
        }
    _B_in = _B_setup()

    return {
        "A_x": _A_in["x"],
        "A_wqkv": _A_in["wqkv"],
        "A_wo": _A_in["wo"],
        "B_x": _B_in["x"],
        "B_w1": _B_in["w1"],
        "B_w2": _B_in["w2"],
    }

def reference(A_x, A_wqkv, A_wo, B_x, B_w1, B_w2):
    def _A_ref(x, wqkv, wo):
        B, S, D = x.shape
        H = 32; Dh = D // H
        qkv = (lambda x, *d: x.permute(*d))((x @ wqkv).reshape(B, S, 3, H, Dh), 2, 0, 3, 1, 4)
        q, k, v = qkv[0], qkv[1], qkv[2]
        scale = Dh ** -0.5
        scores = torch.einsum("bhqd,bhkd->bhqk", q, k) * scale
        p = _softmax(scores, axis=-1)
        o = torch.einsum("bhqk,bhkd->bhqd", p, v)
        return (lambda x, *d: x.permute(*d))(o, 0, 2, 1, 3).reshape(B, S, D) @ wo

    def _B_ref(x, w1, w2):
        h = torch.einsum("bsd,df->bsf", x, w1)
        zero = torch.zeros_like(h)
        h = torch.maximum(h, zero)
        return torch.einsum("bsf,fd->bsd", h, w2)

    x = A_x
    h = x + _A_ref(_layernorm(x, axis=-1), A_wqkv, A_wo)
    h2 = h + _B_ref(_layernorm(h, axis=-1), B_w1, B_w2)
    return h2
```

```asm
; @launch grid=(256,1,1) block=(768,1,1) lds=163840
.amdgcn_target "amdgcn-amd-amdhsa--gfx950"
.text
.globl sequential_preLN__softmax_full_mha__dense_activation_relu__prompt_kernel
.p2align 8
.type sequential_preLN__softmax_full_mha__dense_activation_relu__prompt_kernel,@function
sequential_preLN__softmax_full_mha__dense_activation_relu__prompt_kernel:
    s_load_dwordx16 s[16:31], s[0:1], 0
    s_load_dwordx2 s[32:33], s[0:1], 64
    s_cmp_ge_u32 s2, 256
    s_cbranch_scc1 sequential_preLN__softmax_full_mha__dense_activation_relu__prompt_kernel_end
    v_lshrrev_b32 v2, 6, v0
    v_and_b32 v1, 63, v0
    v_readfirstlane_b32 s3, v2
    s_and_b32 s40, s2, 7
    s_xor_b32 s40, s40, 0
    s_lshr_b32 s41, s2, 3
    s_cmp_ge_u32 s3, 8
    s_cbranch_scc1 xa1
    s_cmp_ge_u32 s3, 4
    s_cbranch_scc1 c1
    s_lshl_b32 s14, s3, 13
    s_cmp_eq_u32 s3, 0
    s_cbranch_scc1 l1_rx
    v_lshrrev_b32 v2, 3, v1
    v_mul_u32_u24 v8, 3072, v2
    v_and_b32 v2, 16, v1
    v_lshrrev_b32 v2, 2, v2
    v_xor_b32 v2, v2, v1
    v_and_b32 v2, 7, v2
    v_lshl_add_u32 v8, v2, 4, v8
    v_mov_b32 v5, 0
    s_movk_i32 s44, 23552
    s_movk_i32 s45, 27648
    s_mov_b32 s13, 196608
    s_sub_u32 s12, s3, 1
    s_lshl_b32 s12, s12, 10
    s_lshl_b32 s7, s40, 7
    s_add_u32 s12, s12, s7
    s_mov_b32 s10, 1572864
    s_waitcnt lgkmcnt(0)
    s_mov_b32 s8, s18
    s_mov_b32 s9, s19
    s_branch l1_rj
l1_rx:
    v_lshrrev_b32 v2, 3, v1
    v_lshlrev_b32 v8, 10, v2
    v_lshrrev_b32 v2, 4, v1
    v_xor_b32 v2, v2, v1
    v_and_b32 v2, 7, v2
    v_lshl_add_u32 v8, v2, 4, v8
    v_mov_b32 v5, 64
    s_movk_i32 s44, 7168
    s_movk_i32 s45, 11264
    s_movk_i32 s13, 128
    s_lshl_b32 s12, s41, 16
    s_mov_b32 s10, 2097152
    s_waitcnt lgkmcnt(0)
    s_mov_b32 s8, s16
    s_mov_b32 s9, s17
l1_rj:
    s_mov_b32 s11, 0x00020000
    v_xad_u32 v9, v8, v5, s44
    v_xad_u32 v10, v9, v5, s44
    v_xad_u32 v11, v10, v5, s44
    v_xad_u32 v12, v11, v5, s45
    v_xad_u32 v13, v12, v5, s44
    v_xad_u32 v14, v13, v5, s44
    v_xad_u32 v15, v14, v5, s44
    s_add_u32 s7, s40, s41
    s_and_b32 s7, s7, 7
    s_lshl_b32 s47, s13, 3
    s_add_u32 s46, s12, s47
    s_mul_i32 s7, s13, s7
    s_add_u32 s12, s12, s7
    s_mov_b32 s15, 0
l1_li:
    s_mov_b32 m0, s14
    s_add_u32 s7, s14, 32768
    buffer_load_dwordx4 v8, s[8:11], s12 offen offset:0 lds
    buffer_load_dwordx4 v9, s[8:11], s12 offen offset:1024 lds
    buffer_load_dwordx4 v10, s[8:11], s12 offen offset:2048 lds
    buffer_load_dwordx4 v11, s[8:11], s12 offen offset:3072 lds
    s_add_u32 m0, s14, 4096
    s_and_b32 s14, s7, 0x1ffff
    buffer_load_dwordx4 v12, s[8:11], s12 offen offset:0 lds
    buffer_load_dwordx4 v13, s[8:11], s12 offen offset:1024 lds
    buffer_load_dwordx4 v14, s[8:11], s12 offen offset:2048 lds
    buffer_load_dwordx4 v15, s[8:11], s12 offen offset:3072 lds
    s_add_u32 s12, s12, s13
    s_cmp_ge_u32 s12, s46
    s_cselect_b32 s7, s47, 0
    s_sub_u32 s12, s12, s7
    s_add_u32 s15, s15, 1
    s_cmp_lt_u32 s15, 3
    s_cbranch_scc1 l1_li
    s_cmp_eq_u32 s15, 8
    s_cbranch_scc1 l1_lt
    s_waitcnt vmcnt(16)
    s_barrier
    s_branch l1_li
l1_lt:
    s_waitcnt vmcnt(16)
    s_barrier
    s_waitcnt vmcnt(8)
    s_barrier
    s_waitcnt vmcnt(0)
    s_barrier
    s_lshr_b32 s42, s41, 3
    s_lshl_b32 s7, s40, 2
    s_add_u32 s42, s42, s7
    v_lshlrev_b32 v8, 4, v1
    v_lshlrev_b32 v9, 2, v1
    s_lshr_b32 s7, s3, 1
    s_and_b32 s46, s3, 1
    s_mul_i32 s47, s46, 5120
    s_lshl_b32 s14, s7, 16
    s_lshl_b32 s12, s42, 16
    s_and_b32 s13, s41, 7
    s_lshl_b32 s13, s13, 2
    s_add_u32 s13, s13, s3
    s_lshl_b32 s13, s13, 11
    s_add_u32 s13, s13, s12
    s_add_u32 s7, s7, 1
    s_lshl_b32 s7, s7, 21
    s_add_u32 s12, s12, s7
    s_lshl_b32 s7, s3, 11
    s_add_u32 m0, s7, 143360
    s_mov_b32 s10, 6291456
    s_mov_b32 s8, s32
    s_mov_b32 s9, s33
    s_lshr_b32 s48, s42, 1
    s_lshl_b32 s48, s48, 8
    s_add_u32 s48, s48, 8192
    s_barrier
    v_mov_b32 v10, 163584
    ds_read_b64 v[10:11], v10
    s_add_u32 s56, s32, 18874368
    s_addc_u32 s57, s33, 0
    s_mov_b32 s58, 327680
    s_mov_b32 s59, 0x00020000
    s_waitcnt lgkmcnt(0)
    v_readfirstlane_b32 s60, v10
    v_readfirstlane_b32 s61, v11
    s_mov_b32 s62, 200000
l2_pl:
    buffer_load_dword v10, v9, s[56:59], s48 offen sc1
    s_sub_u32 s62, s62, 1
    s_waitcnt vmcnt(0)
    v_cmp_ne_u32 vcc, s60, v10
    s_cbranch_scc1 l2_pd
    s_cbranch_vccnz l2_pl
l2_pd:
    s_cmp_eq_u32 s61, 0
    s_cbranch_scc1 l2_inv
l2_ib:
    buffer_load_dwordx4 v8, s[8:11], s13 offen sc1 lds
    buffer_load_dwordx4 v8, s[8:11], s13 offen offset:1024 sc1 lds
    s_add_u32 m0, s14, s47
    s_add_u32 s13, s12, s47
    buffer_load_dwordx4 v8, s[8:11], s13 offen offset:0 sc1 lds
    buffer_load_dwordx4 v8, s[8:11], s13 offen offset:1024 sc1 lds
    buffer_load_dwordx4 v8, s[8:11], s13 offen offset:2048 sc1 lds
    buffer_load_dwordx4 v8, s[8:11], s13 offen offset:3072 sc1 lds
    s_add_u32 m0, m0, 4096
    s_add_u32 s13, s13, 4096
    s_lshl_b32 s47, s46, 12
    s_add_u32 s47, s47, 10240
    buffer_load_dwordx4 v8, s[8:11], s13 offen sc1 lds
    s_add_u32 m0, s14, s47
    s_add_u32 s13, s12, s47
    s_mul_i32 s47, s46, 23552
    s_add_u32 s47, s47, 18432
    buffer_load_dwordx4 v8, s[8:11], s13 offen offset:0 sc1 lds
    buffer_load_dwordx4 v8, s[8:11], s13 offen offset:1024 sc1 lds
    buffer_load_dwordx4 v8, s[8:11], s13 offen offset:2048 sc1 lds
    buffer_load_dwordx4 v8, s[8:11], s13 offen offset:3072 sc1 lds
    s_add_u32 m0, s14, s47
    s_add_u32 s13, s12, s47
    buffer_load_dwordx4 v8, s[8:11], s13 offen offset:0 sc1 lds
    buffer_load_dwordx4 v8, s[8:11], s13 offen offset:1024 sc1 lds
    s_waitcnt vmcnt(6)
    s_barrier
    buffer_load_dwordx4 v8, s[8:11], s13 offen offset:2048 sc1 lds
    buffer_load_dwordx4 v8, s[8:11], s13 offen offset:3072 sc1 lds
    s_add_u32 m0, m0, 4096
    s_add_u32 s13, s13, 4096
    buffer_load_dwordx4 v8, s[8:11], s13 offen offset:0 sc1 lds
    buffer_load_dwordx4 v8, s[8:11], s13 offen offset:1024 sc1 lds
    buffer_load_dwordx4 v8, s[8:11], s13 offen offset:2048 sc1 lds
    buffer_load_dwordx4 v8, s[8:11], s13 offen offset:3072 sc1 lds
    s_add_u32 m0, m0, 4096
    s_add_u32 s13, s13, 4096
    buffer_load_dwordx4 v8, s[8:11], s13 offen offset:0 sc1 lds
    buffer_load_dwordx4 v8, s[8:11], s13 offen offset:1024 sc1 lds
    buffer_load_dwordx4 v8, s[8:11], s13 offen offset:2048 sc1 lds
    buffer_load_dwordx4 v8, s[8:11], s13 offen offset:3072 sc1 lds
    s_add_u32 m0, m0, 4096
    s_add_u32 s13, s13, 4096
    buffer_load_dwordx4 v8, s[8:11], s13 offen offset:0 sc1 lds
    buffer_load_dwordx4 v8, s[8:11], s13 offen offset:1024 sc1 lds
    buffer_load_dwordx4 v8, s[8:11], s13 offen offset:2048 sc1 lds
    buffer_load_dwordx4 v8, s[8:11], s13 offen offset:3072 sc1 lds
    s_add_u32 m0, m0, 4096
    s_add_u32 s13, s13, 4096
    buffer_load_dwordx4 v8, s[8:11], s13 offen offset:0 sc1 lds
    buffer_load_dwordx4 v8, s[8:11], s13 offen offset:1024 sc1 lds
    buffer_load_dwordx4 v8, s[8:11], s13 offen offset:2048 sc1 lds
    buffer_load_dwordx4 v8, s[8:11], s13 offen offset:3072 sc1 lds
    s_add_u32 m0, m0, 4096
    s_add_u32 s13, s13, 4096
    buffer_load_dwordx4 v8, s[8:11], s13 offen offset:0 sc1 lds
    buffer_load_dwordx4 v8, s[8:11], s13 offen offset:1024 sc1 lds
    buffer_load_dwordx4 v8, s[8:11], s13 offen offset:2048 sc1 lds
    s_waitcnt vmcnt(23)
    s_barrier
    s_waitcnt vmcnt(0)
    s_barrier
    s_mov_b32 s48, 0
    s_cmp_lg_u32 s3, 0
    s_cbranch_scc1 l2_pf
    s_cmp_ge_u32 s2, 112
    s_cbranch_scc1 l2_pf
    v_lshrrev_b32 v2, 3, v1
    v_mul_u32_u24 v16, 3584, v2
    v_and_b32 v2, 16, v1
    v_lshrrev_b32 v2, 2, v2
    v_xor_b32 v2, v2, v1
    v_and_b32 v2, 7, v2
    v_lshl_add_u32 v16, v2, 4, v16
    s_mov_b32 s36, s24
    s_mov_b32 s37, s25
    s_mov_b32 s38, 1835008
    s_mov_b32 s39, 0x00020000
    s_and_b32 s44, s2, 3
    s_lshr_b32 s45, s2, 2
    s_mul_i32 s13, s44, 458752
    s_lshl_b32 s7, s45, 7
    s_add_u32 s13, s13, s7
    s_mov_b32 m0, 143360
    s_mov_b32 s15, 0
l2_c1:
    buffer_load_dwordx4 v16, s[36:39], s13 offen lds
    s_add_u32 m0, m0, 1024
    s_add_u32 s13, s13, 28672
    s_add_u32 s15, s15, 1
    s_cmp_lt_u32 s15, 16
    s_cbranch_scc1 l2_c1
    v_and_b32 v2, 44, v1
    v_lshlrev_b32 v17, 5, v2
    v_and_b32 v2, 16, v1
    v_lshl_or_b32 v17, v2, 1, v17
    v_and_b32 v2, 2, v1
    v_lshl_or_b32 v17, v2, 2, v17
    v_and_b32 v2, 1, v1
    v_lshl_or_b32 v17, v2, 4, v17
    v_and_b32 v2, 8, v1
    v_lshl_or_b32 v17, v2, 3, v17
    v_add_u32 v17, 143360, v17
    v_xor_b32 v18, 64, v17
    v_mov_b32 v20, 0x3f803f80
    v_mov_b32 v21, v20
    v_mov_b32 v22, v20
    v_mov_b32 v23, v20
    v_mov_b32 v32, 0
    v_mov_b32 v33, 0
    v_mov_b32 v34, 0
    v_mov_b32 v35, 0
    v_mov_b32 v36, 0
    v_mov_b32 v37, 0
    v_mov_b32 v38, 0
    v_mov_b32 v39, 0
    v_mov_b32 v40, 0
    v_mov_b32 v41, 0
    v_mov_b32 v42, 0
    v_mov_b32 v43, 0
    v_mov_b32 v44, 0
    v_mov_b32 v45, 0
    v_mov_b32 v46, 0
    v_mov_b32 v47, 0
    v_mov_b32 v48, 0
    v_mov_b32 v49, 0
    v_mov_b32 v50, 0
    v_mov_b32 v51, 0
    v_mov_b32 v52, 0
    v_mov_b32 v53, 0
    v_mov_b32 v54, 0
    v_mov_b32 v55, 0
    v_mov_b32 v56, 0
    v_mov_b32 v57, 0
    v_mov_b32 v58, 0
    v_mov_b32 v59, 0
    v_mov_b32 v60, 0
    v_mov_b32 v61, 0
    v_mov_b32 v62, 0
    v_mov_b32 v63, 0
    s_mov_b32 s15, 0
    s_waitcnt vmcnt(0)
l2_c2:
    ds_read_b64_tr_b16 v[24:25], v17
    ds_read_b64_tr_b16 v[26:27], v17 offset:512
    ds_read_b64_tr_b16 v[28:29], v18
    ds_read_b64_tr_b16 v[30:31], v18 offset:512
    v_add_u32 v17, 2048, v17
    v_add_u32 v18, 2048, v18
    s_add_u32 s15, s15, 1
    s_cmp_lt_u32 s15, 8
    s_waitcnt lgkmcnt(0)
    v_mfma_f32_32x32x16_bf16 v[32:47], v[20:23], v[24:27], v[32:47]
    v_mfma_f32_32x32x16_bf16 v[48:63], v[20:23], v[28:31], v[48:63]
    s_cbranch_scc1 l2_c2
    s_add_u32 s36, s32, 18350080
    s_addc_u32 s37, s33, 0
    s_mov_b32 s38, 28672
    s_mov_b32 s39, 0x00020000
    v_cmp_gt_u32 vcc, 32, v1
    s_lshl_b32 s13, s45, 10
    s_lshl_b32 s7, s44, 2
    s_add_u32 s13, s13, s7
    s_lshl_b32 s48, s2, 2
    s_add_u32 s48, s48, 40960
    s_nop 5
    v_cndmask_b32 v2, v48, v32, vcc
    buffer_store_dword v2, v8, s[36:39], s13 offen sc1
    v_mov_b32 v3, s60
    s_waitcnt vmcnt(0)
    s_mov_b64 exec, 1
    buffer_store_dword v3, off, s[56:59], s48 sc1
    s_mov_b64 exec, -1
l2_pf:
    s_lshl_b32 s7, s41, 2
    s_add_u32 s7, s7, s3
    s_mul_i32 s50, s7, 14336
    s_lshl_b32 s51, s7, 12
    s_lshl_b32 s7, s2, 2
    s_add_u32 s7, s7, s3
    s_mul_i32 s53, s7, 1792
    s_mov_b32 s36, s26
    s_mov_b32 s37, s27
    s_mov_b32 s38, 1835008
    s_mov_b32 s39, 0x00020000
    s_mov_b32 s52, s50
    buffer_load_dwordx4 v[12:15], v8, s[36:39], s53 offen offset:0
    buffer_load_dwordx4 v[12:15], v8, s[36:39], s53 offen offset:1024
    s_mov_b32 s36, s24
    s_mov_b32 s37, s25
    s_mov_b32 s38, 1835008
    s_mov_b32 s39, 0x00020000
    buffer_load_dwordx4 v[12:15], v8, s[36:39], s52 offen offset:0
    buffer_load_dwordx4 v[12:15], v8, s[36:39], s52 offen offset:1024
    buffer_load_dwordx4 v[12:15], v8, s[36:39], s52 offen offset:2048
    buffer_load_dwordx4 v[12:15], v8, s[36:39], s52 offen offset:3072
    s_add_u32 s52, s52, 4096
    buffer_load_dwordx4 v[12:15], v8, s[36:39], s52 offen offset:0
    buffer_load_dwordx4 v[12:15], v8, s[36:39], s52 offen offset:1024
    buffer_load_dwordx4 v[12:15], v8, s[36:39], s52 offen offset:2048
    buffer_load_dwordx4 v[12:15], v8, s[36:39], s52 offen offset:3072
    s_add_u32 s52, s52, 4096
    buffer_load_dwordx4 v[12:15], v8, s[36:39], s52 offen offset:0
    buffer_load_dwordx4 v[12:15], v8, s[36:39], s52 offen offset:1024
    buffer_load_dwordx4 v[12:15], v8, s[36:39], s52 offen offset:2048
    buffer_load_dwordx4 v[12:15], v8, s[36:39], s52 offen offset:3072
    s_add_u32 s52, s52, 4096
    buffer_load_dwordx4 v[12:15], v8, s[36:39], s52 offen offset:0
    buffer_load_dwordx4 v[12:15], v8, s[36:39], s52 offen offset:1024
    s_mov_b32 s36, s20
    s_mov_b32 s37, s21
    s_mov_b32 s38, 524288
    s_mov_b32 s39, 0x00020000
    buffer_load_dwordx4 v[12:15], v8, s[36:39], s51 offen offset:0
    buffer_load_dwordx4 v[12:15], v8, s[36:39], s51 offen offset:1024
    buffer_load_dwordx4 v[12:15], v8, s[36:39], s51 offen offset:2048
    buffer_load_dwordx4 v[12:15], v8, s[36:39], s51 offen offset:3072
    s_lshr_b32 s42, s41, 3
    s_lshl_b32 s7, s40, 2
    s_add_u32 s42, s42, s7
    s_and_b32 s43, s41, 7
    s_add_u32 s36, s32, 8388608
    s_addc_u32 s37, s33, 0
    s_mov_b32 s38, 10485760
    s_mov_b32 s39, 0x00020000
    s_and_b32 s7, s3, 1
    s_lshl_b32 s50, s42, 1
    s_add_u32 s50, s50, s7
    s_lshl_b32 s51, s50, 12
    s_lshl_b32 s50, s50, 15
    s_lshl_b32 s7, s43, 12
    s_add_u32 s50, s50, s7
    s_lshr_b32 s7, s43, 1
    s_lshl_b32 s7, s7, 10
    s_add_u32 s51, s51, s7
    s_add_u32 s51, s51, 9437184
    buffer_load_dwordx4 v[12:15], v8, s[36:39], s50 offen offset:0
    buffer_load_dwordx4 v[12:15], v8, s[36:39], s50 offen offset:1024
    buffer_load_dwordx4 v[12:15], v8, s[36:39], s50 offen offset:2048
    buffer_load_dwordx4 v[12:15], v8, s[36:39], s50 offen offset:3072
    buffer_load_dwordx4 v[12:15], v8, s[36:39], s51 offen
    s_cmp_ge_u32 s41, 28
    s_cbranch_scc1 l2_pr4
    s_cmp_ge_u32 s41, 14
    s_cselect_b32 s42, 1, 0
    s_cselect_b32 s7, 14, 0
    s_sub_u32 s43, s41, s7
    s_lshl_b32 s7, s40, 1
    s_add_u32 s42, s42, s7
    s_add_u32 s36, s32, 10485760
    s_addc_u32 s37, s33, 0
    s_mov_b32 s38, 7340032
    s_mov_b32 s39, 0x00020000
    s_lshl_b32 s50, s42, 2
    s_add_u32 s50, s50, s3
    s_mul_i32 s50, s50, 112
    s_lshl_b32 s7, s43, 3
    s_add_u32 s50, s50, s7
    s_lshl_b32 s50, s50, 10
    s_add_u32 s51, s50, 4096
    buffer_load_dwordx4 v[12:15], v8, s[36:39], s50 offen offset:0
    buffer_load_dwordx4 v[12:15], v8, s[36:39], s50 offen offset:1024
    buffer_load_dwordx4 v[12:15], v8, s[36:39], s50 offen offset:2048
    buffer_load_dwordx4 v[12:15], v8, s[36:39], s50 offen offset:3072
    buffer_load_dwordx4 v[12:15], v8, s[36:39], s51 offen offset:0
    buffer_load_dwordx4 v[12:15], v8, s[36:39], s51 offen offset:1024
    buffer_load_dwordx4 v[12:15], v8, s[36:39], s51 offen offset:2048
    buffer_load_dwordx4 v[12:15], v8, s[36:39], s51 offen offset:3072
l2_pr4:
    s_waitcnt vmcnt(0)
    s_cmp_ge_u32 s3, 2
    s_cbranch_scc1 lw3
    s_lshr_b32 s42, s41, 3
    s_lshl_b32 s7, s40, 2
    s_add_u32 s42, s42, s7
    s_and_b32 s43, s41, 7
    s_lshl_b32 s14, s3, 13
    v_lshlrev_b32 v8, 4, v1
    s_movk_i32 s44, 0
    s_movk_i32 s45, 4096
    s_movk_i32 s13, 8192
    s_lshl_b32 s12, s42, 1
    s_add_u32 s12, s12, s3
    s_mul_i32 s12, s12, 32768
    s_mov_b32 s10, 2097152
    s_add_u32 s8, s32, 6291456
    s_addc_u32 s9, s33, 0
    v_add_u32 v9, s44, v8
    v_add_u32 v10, s44, v9
    v_add_u32 v11, s44, v10
    v_add_u32 v12, s45, v11
    v_add_u32 v13, s44, v12
    v_add_u32 v14, s44, v13
    v_add_u32 v15, s44, v14
    v_and_b32 v5, 31, v1
    v_lshlrev_b32 v5, 6, v5
    s_lshl_b32 s48, s42, 1
    s_add_u32 s48, s48, s3
    s_lshl_b32 s48, s48, 11
    s_add_u32 s48, s48, 65536
    s_barrier
    s_mov_b32 s62, 200000
lx3_pl:
    buffer_load_dword v6, v5, s[56:59], s48 offen sc1
    s_sub_u32 s62, s62, 1
    s_waitcnt vmcnt(0)
    v_cmp_ne_u32 vcc, s60, v6
    s_cbranch_scc1 lx3_pd
    s_cbranch_vccnz lx3_pl
lx3_pd:
    s_or_b32 s7, s2, s3
    s_cbranch_scc0 lx3_ep
lx3_eb:
    s_mov_b32 s15, 0
lx3_li:
    s_mov_b32 m0, s14
    s_add_u32 s7, s14, 32768
    buffer_load_dwordx4 v8, s[8:11], s12 offen offset:0 sc1 lds
    buffer_load_dwordx4 v9, s[8:11], s12 offen offset:1024 sc1 lds
    buffer_load_dwordx4 v10, s[8:11], s12 offen offset:2048 sc1 lds
    buffer_load_dwordx4 v11, s[8:11], s12 offen offset:3072 sc1 lds
    s_add_u32 m0, s14, 4096
    s_and_b32 s14, s7, 0x1ffff
    buffer_load_dwordx4 v12, s[8:11], s12 offen offset:0 sc1 lds
    buffer_load_dwordx4 v13, s[8:11], s12 offen offset:1024 sc1 lds
    buffer_load_dwordx4 v14, s[8:11], s12 offen offset:2048 sc1 lds
    buffer_load_dwordx4 v15, s[8:11], s12 offen offset:3072 sc1 lds
    s_add_u32 s12, s12, s13
    s_add_u32 s15, s15, 1
    s_cmp_lt_u32 s15, 4
    s_cbranch_scc1 lx3_li
    s_cmp_eq_u32 s15, 4
    s_cbranch_scc1 lx3_lt
    s_waitcnt vmcnt(24)
    s_barrier
    s_branch lx3_li
lx3_lt:
    s_waitcnt vmcnt(24)
    s_barrier
    s_waitcnt vmcnt(16)
    s_barrier
    s_waitcnt vmcnt(8)
    s_barrier
    s_waitcnt vmcnt(0)
    s_barrier
    s_cmp_ge_u32 s41, 28
    s_cbranch_scc1 lx4_skip
    s_cmp_ge_u32 s41, 14
    s_cselect_b32 s42, 1, 0
    s_cselect_b32 s7, 14, 0
    s_sub_u32 s43, s41, s7
    s_lshl_b32 s7, s40, 1
    s_add_u32 s42, s42, s7
    v_lshlrev_b32 v6, 4, v1
    v_and_b32 v7, 7, v1
    v_lshlrev_b32 v7, 2, v7
    s_lshl_b32 s48, s43, 5
    s_add_u32 s48, s48, 40960
    s_mov_b32 s62, 200000
lx4c_pl:
    buffer_load_dword v5, v7, s[56:59], s48 offen sc1
    s_sub_u32 s62, s62, 1
    s_waitcnt vmcnt(0)
    v_cmp_ne_u32 vcc, s60, v5
    s_cbranch_scc1 lx4c_pd
    s_cbranch_vccnz lx4c_pl
lx4c_pd:
    s_add_u32 s36, s32, 17825792
    s_addc_u32 s37, s33, 0
    s_mov_b32 s38, 1048576
    s_mov_b32 s39, 0x00020000
    s_lshl_b32 s46, s42, 2
    s_add_u32 s46, s46, s3
    s_lshl_b32 s46, s46, 12
    s_lshl_b32 s47, s43, 2
    s_add_u32 s47, s47, s3
    s_lshl_b32 s47, s47, 9
    s_add_u32 s47, s47, 524288
    v_and_b32 v7, 0x1f0, v6
    buffer_load_dwordx4 v[32:35], v7, s[36:39], s47 offen sc1
    v_mov_b32 v8, v6
    s_lshl_b32 s14, s3, 13
    s_movk_i32 s44, 0
    s_mov_b32 s45, 32768
    s_movk_i32 s13, 4096
    s_lshl_b32 s12, s42, 17
    s_lshl_b32 s7, s3, 16
    s_add_u32 s12, s12, s7
    s_mov_b32 s10, 2097152
    s_add_u32 s8, s32, 8388608
    s_addc_u32 s9, s33, 0
    v_lshlrev_b32 v5, 2, v1
    s_lshl_b32 s48, s42, 8
    s_add_u32 s48, s48, 24576
    v_add_u32 v9, s44, v8
    v_add_u32 v10, s44, v9
    v_add_u32 v11, s44, v10
    v_add_u32 v12, s45, v11
    v_add_u32 v13, s44, v12
    v_add_u32 v14, s44, v13
    v_add_u32 v15, s44, v14
    s_barrier
    s_mov_b32 s62, 200000
lx4_pl:
    buffer_load_dword v7, v5, s[56:59], s48 offen sc1
    s_sub_u32 s62, s62, 1
    s_waitcnt vmcnt(0)
    v_cmp_ne_u32 vcc, s60, v7
    s_cbranch_scc1 lx4_pd
    s_cbranch_vccnz lx4_pl
lx4_pd:
    s_cmp_eq_u32 s61, 0
    s_cbranch_scc1 lx4_inv
lx4_ib:
    s_mov_b32 s15, 0
lx4_li:
    s_mov_b32 m0, s14
    s_add_u32 s7, s14, 32768
    buffer_load_dwordx4 v8, s[8:11], s12 offen offset:0 sc1 lds
    buffer_load_dwordx4 v9, s[8:11], s12 offen offset:1024 sc1 lds
    buffer_load_dwordx4 v10, s[8:11], s12 offen offset:2048 sc1 lds
    buffer_load_dwordx4 v11, s[8:11], s12 offen offset:3072 sc1 lds
    s_add_u32 m0, s14, 4096
    s_and_b32 s14, s7, 0x1ffff
    buffer_load_dwordx4 v12, s[8:11], s12 offen offset:0 sc1 lds
    buffer_load_dwordx4 v13, s[8:11], s12 offen offset:1024 sc1 lds
    buffer_load_dwordx4 v14, s[8:11], s12 offen offset:2048 sc1 lds
    buffer_load_dwordx4 v15, s[8:11], s12 offen offset:3072 sc1 lds
    s_add_u32 s12, s12, s13
    s_add_u32 s15, s15, 1
    s_cmp_lt_u32 s15, 2
    s_cbranch_scc1 lx4_li
    s_cmp_eq_u32 s15, 8
    s_cbranch_scc1 lx4_lt
    s_waitcnt vmcnt(8)
    s_barrier
    s_branch lx4_li
lx4_lt:
    buffer_load_dwordx4 v[16:19], v6, s[36:39], s46 offen offset:0 sc1
    buffer_load_dwordx4 v[20:23], v6, s[36:39], s46 offen offset:1024 sc1
    buffer_load_dwordx4 v[24:27], v6, s[36:39], s46 offen offset:2048 sc1
    buffer_load_dwordx4 v[28:31], v6, s[36:39], s46 offen offset:3072 sc1
    s_waitcnt vmcnt(12)
    s_barrier
    s_waitcnt vmcnt(4)
    s_barrier
    s_branch l4_st
lx4_skip:
    s_barrier
lx5:
    s_lshr_b32 s42, s41, 3
    s_lshl_b32 s7, s40, 2
    s_add_u32 s42, s42, s7
    s_and_b32 s43, s41, 7
    s_lshl_b32 s14, s3, 13
    v_lshlrev_b32 v8, 4, v1
    s_movk_i32 s44, 0
    s_movk_i32 s45, 4096
    s_movk_i32 s13, 8192
    s_lshl_b32 s12, s42, 1
    s_add_u32 s12, s12, s3
    s_mul_i32 s12, s12, 114688
    s_mov_b32 s10, 7340032
    s_add_u32 s8, s32, 10485760
    s_addc_u32 s9, s33, 0
    v_add_u32 v9, s44, v8
    v_add_u32 v10, s44, v9
    v_add_u32 v11, s44, v10
    v_add_u32 v12, s45, v11
    v_add_u32 v13, s44, v12
    v_add_u32 v14, s44, v13
    v_add_u32 v15, s44, v14
    v_min_u32 v5, 27, v1
    v_lshlrev_b32 v5, 2, v5
    s_lshl_b32 s48, s42, 7
    s_add_u32 s48, s48, 32768
    s_cmp_ge_u32 s41, 28
    s_cbranch_scc1 lx5_nb
    s_barrier
lx5_nb:
    s_mov_b32 s62, 200000
lx5_pl:
    buffer_load_dword v6, v5, s[56:59], s48 offen sc1
    s_sub_u32 s62, s62, 1
    s_waitcnt vmcnt(0)
    v_cmp_ne_u32 vcc, s60, v6
    s_cbranch_scc1 lx5_pd
    s_cbranch_vccnz lx5_pl
lx5_pd:
    s_cmp_eq_u32 s61, 0
    s_cbranch_scc1 lx5_inv
lx5_ib:
    s_mov_b32 s15, 0
    s_branch lx5_la
lx5_li:
    s_add_u32 m0, s14, 4096
    s_and_b32 s14, s7, 0x1ffff
    buffer_load_dwordx4 v12, s[8:11], s12 offen offset:0 sc1 lds
    buffer_load_dwordx4 v13, s[8:11], s12 offen offset:1024 sc1 lds
    buffer_load_dwordx4 v14, s[8:11], s12 offen offset:2048 sc1 lds
    buffer_load_dwordx4 v15, s[8:11], s12 offen offset:3072 sc1 lds
    s_add_u32 s12, s12, s13
    s_add_u32 s15, s15, 1
    s_cmp_eq_u32 s15, 14
    s_cbranch_scc1 lx5_lt
lx5_la:
    s_mov_b32 m0, s14
    s_add_u32 s7, s14, 32768
    buffer_load_dwordx4 v8, s[8:11], s12 offen offset:0 sc1 lds
    buffer_load_dwordx4 v9, s[8:11], s12 offen offset:1024 sc1 lds
    buffer_load_dwordx4 v10, s[8:11], s12 offen offset:2048 sc1 lds
    buffer_load_dwordx4 v11, s[8:11], s12 offen offset:3072 sc1 lds
    s_cmp_lt_u32 s15, 2
    s_cbranch_scc1 lx5_li
    s_waitcnt vmcnt(12)
    s_barrier
    s_branch lx5_li
lx5_lt:
    s_waitcnt vmcnt(8)
    s_barrier
    s_waitcnt vmcnt(0)
    s_barrier
    s_endpgm
lw3:
    s_lshr_b32 s42, s41, 3
    s_lshl_b32 s7, s40, 2
    s_add_u32 s42, s42, s7
    s_and_b32 s43, s41, 7
    v_lshrrev_b32 v2, 3, v1
    v_mul_u32_u24 v8, 1024, v2
    v_and_b32 v2, 16, v1
    v_lshrrev_b32 v2, 2, v2
    v_xor_b32 v2, v2, v1
    v_and_b32 v2, 7, v2
    v_lshl_add_u32 v8, v2, 4, v8
    s_lshl_b32 s14, s3, 13
    s_movk_i32 s44, 7168
    s_movk_i32 s45, 11264
    s_mov_b32 s13, 131072
    s_sub_u32 s12, s3, 2
    s_lshl_b32 s12, s12, 16
    s_lshl_b32 s7, s43, 7
    s_add_u32 s12, s12, s7
    s_mov_b32 s10, 524288
    s_mov_b32 s8, s20
    s_mov_b32 s9, s21
    v_add_u32 v9, s44, v8
    v_add_u32 v10, s44, v9
    v_add_u32 v11, s44, v10
    v_add_u32 v12, s45, v11
    v_add_u32 v13, s44, v12
    v_add_u32 v14, s44, v13
    v_add_u32 v15, s44, v14
    s_barrier
    s_mov_b32 s15, 0
lw3_w0:
    s_mov_b32 m0, s14
    s_add_u32 s7, s14, 32768
    buffer_load_dwordx4 v8, s[8:11], s12 offen offset:0 lds
    buffer_load_dwordx4 v9, s[8:11], s12 offen offset:1024 lds
    buffer_load_dwordx4 v10, s[8:11], s12 offen offset:2048 lds
    buffer_load_dwordx4 v11, s[8:11], s12 offen offset:3072 lds
    s_add_u32 m0, s14, 4096
    s_and_b32 s14, s7, 0x1ffff
    buffer_load_dwordx4 v12, s[8:11], s12 offen offset:0 lds
    buffer_load_dwordx4 v13, s[8:11], s12 offen offset:1024 lds
    buffer_load_dwordx4 v14, s[8:11], s12 offen offset:2048 lds
    buffer_load_dwordx4 v15, s[8:11], s12 offen offset:3072 lds
    s_add_u32 s12, s12, s13
    s_add_u32 s15, s15, 1
    s_cmp_lt_u32 s15, 4
    s_cbranch_scc1 lw3_w0
    s_waitcnt vmcnt(24)
    s_barrier
    s_waitcnt vmcnt(16)
    s_barrier
    s_waitcnt vmcnt(8)
    s_barrier
    s_waitcnt vmcnt(0)
    s_barrier
    s_cmp_ge_u32 s41, 28
    s_cbranch_scc1 lw4_skip
    s_cmp_ge_u32 s41, 14
    s_cselect_b32 s42, 1, 0
    s_cselect_b32 s7, 14, 0
    s_sub_u32 s43, s41, s7
    s_lshl_b32 s7, s40, 1
    s_add_u32 s42, s42, s7
    v_lshlrev_b32 v6, 4, v1
    v_and_b32 v7, 7, v1
    v_lshlrev_b32 v7, 2, v7
    s_lshl_b32 s48, s43, 5
    s_add_u32 s48, s48, 40960
    s_mov_b32 s62, 200000
lw4c_pl:
    buffer_load_dword v5, v7, s[56:59], s48 offen sc1
    s_sub_u32 s62, s62, 1
    s_waitcnt vmcnt(0)
    v_cmp_ne_u32 vcc, s60, v5
    s_cbranch_scc1 lw4c_pd
    s_cbranch_vccnz lw4c_pl
lw4c_pd:
    s_add_u32 s36, s32, 17825792
    s_addc_u32 s37, s33, 0
    s_mov_b32 s38, 1048576
    s_mov_b32 s39, 0x00020000
    s_lshl_b32 s46, s42, 2
    s_add_u32 s46, s46, s3
    s_lshl_b32 s46, s46, 12
    s_lshl_b32 s47, s43, 2
    s_add_u32 s47, s47, s3
    s_lshl_b32 s47, s47, 9
    s_add_u32 s47, s47, 524288
    v_and_b32 v7, 0x1f0, v6
    buffer_load_dwordx4 v[32:35], v7, s[36:39], s47 offen sc1
    v_lshrrev_b32 v2, 3, v1
    v_mul_u32_u24 v8, 3584, v2
    v_and_b32 v2, 16, v1
    v_lshrrev_b32 v2, 2, v2
    v_xor_b32 v2, v2, v1
    v_and_b32 v2, 7, v2
    v_lshl_add_u32 v8, v2, 4, v8
    s_lshl_b32 s14, s3, 13
    s_movk_i32 s44, 27648
    s_movk_i32 s45, 31744
    s_mov_b32 s13, 229376
    s_sub_u32 s12, s3, 2
    s_lshl_b32 s12, s12, 7
    s_lshl_b32 s7, s43, 8
    s_add_u32 s12, s12, s7
    s_mov_b32 s10, 1835008
    s_mov_b32 s8, s24
    s_mov_b32 s9, s25
    v_add_u32 v9, s44, v8
    v_add_u32 v10, s44, v9
    v_add_u32 v11, s44, v10
    v_add_u32 v12, s45, v11
    v_add_u32 v13, s44, v12
    v_add_u32 v14, s44, v13
    v_add_u32 v15, s44, v14
    s_barrier
    s_mov_b32 s15, 0
lw4_w0:
    s_mov_b32 m0, s14
    s_add_u32 s7, s14, 32768
    buffer_load_dwordx4 v8, s[8:11], s12 offen offset:0 lds
    buffer_load_dwordx4 v9, s[8:11], s12 offen offset:1024 lds
    buffer_load_dwordx4 v10, s[8:11], s12 offen offset:2048 lds
    buffer_load_dwordx4 v11, s[8:11], s12 offen offset:3072 lds
    s_add_u32 m0, s14, 4096
    s_and_b32 s14, s7, 0x1ffff
    buffer_load_dwordx4 v12, s[8:11], s12 offen offset:0 lds
    buffer_load_dwordx4 v13, s[8:11], s12 offen offset:1024 lds
    buffer_load_dwordx4 v14, s[8:11], s12 offen offset:2048 lds
    buffer_load_dwordx4 v15, s[8:11], s12 offen offset:3072 lds
    s_add_u32 s12, s12, s13
    s_add_u32 s15, s15, 1
    s_cmp_lt_u32 s15, 4
    s_cbranch_scc1 lw4_w0
    s_waitcnt vmcnt(24)
    s_barrier
    s_waitcnt vmcnt(16)
    s_barrier
lw4_w1:
    s_waitcnt vmcnt(8)
    s_barrier
    s_mov_b32 m0, s14
    s_add_u32 s7, s14, 32768
    buffer_load_dwordx4 v8, s[8:11], s12 offen offset:0 lds
    buffer_load_dwordx4 v9, s[8:11], s12 offen offset:1024 lds
    buffer_load_dwordx4 v10, s[8:11], s12 offen offset:2048 lds
    buffer_load_dwordx4 v11, s[8:11], s12 offen offset:3072 lds
    s_add_u32 m0, s14, 4096
    s_and_b32 s14, s7, 0x1ffff
    buffer_load_dwordx4 v12, s[8:11], s12 offen offset:0 lds
    buffer_load_dwordx4 v13, s[8:11], s12 offen offset:1024 lds
    buffer_load_dwordx4 v14, s[8:11], s12 offen offset:2048 lds
    buffer_load_dwordx4 v15, s[8:11], s12 offen offset:3072 lds
    s_add_u32 s12, s12, s13
    s_add_u32 s15, s15, 1
    s_cmp_lt_u32 s15, 8
    s_cbranch_scc1 lw4_w1
    buffer_load_dwordx4 v[16:19], v6, s[36:39], s46 offen offset:0 sc1
    buffer_load_dwordx4 v[20:23], v6, s[36:39], s46 offen offset:1024 sc1
    buffer_load_dwordx4 v[24:27], v6, s[36:39], s46 offen offset:2048 sc1
    buffer_load_dwordx4 v[28:31], v6, s[36:39], s46 offen offset:3072 sc1
    s_waitcnt vmcnt(12)
    s_barrier
    s_waitcnt vmcnt(4)
    s_barrier
l4_st:
    v_cmp_gt_u32 vcc, 32, v1
    s_lshl_b32 s7, s3, 10
    s_add_u32 s7, s7, 131072
    v_add_u32 v6, s7, v6
    s_waitcnt vmcnt(0)
    v_pk_add_f32 v[16:17], v[16:17], v[20:21]
    v_pk_add_f32 v[18:19], v[18:19], v[22:23]
    v_pk_add_f32 v[16:17], v[16:17], v[24:25]
    v_pk_add_f32 v[18:19], v[18:19], v[26:27]
    v_pk_add_f32 v[16:17], v[16:17], v[28:29]
    v_pk_add_f32 v[18:19], v[18:19], v[30:31]
    v_pk_add_f32 v[32:33], v[32:33], v[34:35]
    v_pk_add_f32 v[16:17], v[16:17], v[18:19]
    v_add_f32 v22, v32, v33
    v_add_f32 v16, v16, v17
    v_mov_b32 v17, v16
    v_and_b32 v23, 0xffff0000, v22
    v_sub_f32 v22, v22, v23
    v_cvt_pk_bf16_f32 v22, v23, v22
    v_permlane32_swap_b32 v16, v17
    v_mul_f32 v16, 0xbb000000, v16
    v_mul_f32 v17, 0x3b000000, v17
    v_fma_f32 v17, -v16, v16, v17
    v_and_b32 v18, 0xffff0000, v16
    v_max_f32 v17, 0, v17
    v_sub_f32 v16, v16, v18
    v_add_f32 v17, 0x3727c5ac, v17
    v_cndmask_b32 v16, v16, v18, vcc
    v_rsq_f32 v21, v17
    v_cvt_pk_bf16_f32 v20, v16, v16
    s_nop 0
    ds_write_b96 v6, v[20:22]
    s_cmp_lt_u32 s3, 2
    s_waitcnt lgkmcnt(0)
    s_barrier
    s_cbranch_scc1 lx5
    s_branch lw5
lw4_skip:
    s_barrier
lw5:
    s_lshr_b32 s42, s41, 3
    s_lshl_b32 s7, s40, 2
    s_add_u32 s42, s42, s7
    s_and_b32 s43, s41, 7
    v_lshrrev_b32 v2, 3, v1
    v_mul_u32_u24 v8, 1024, v2
    v_and_b32 v2, 16, v1
    v_lshrrev_b32 v2, 2, v2
    v_xor_b32 v2, v2, v1
    v_and_b32 v2, 7, v2
    v_lshl_add_u32 v8, v2, 4, v8
    s_lshl_b32 s14, s3, 13
    s_movk_i32 s44, 7168
    s_movk_i32 s45, 11264
    s_mov_b32 s13, 131072
    s_sub_u32 s12, s3, 2
    s_lshl_b32 s12, s12, 16
    s_lshl_b32 s7, s43, 7
    s_add_u32 s12, s12, s7
    s_mov_b32 s10, 1835008
    s_mov_b32 s8, s26
    s_mov_b32 s9, s27
    v_add_u32 v9, s44, v8
    v_add_u32 v10, s44, v9
    v_add_u32 v11, s44, v10
    v_add_u32 v12, s45, v11
    v_add_u32 v13, s44, v12
    v_add_u32 v14, s44, v13
    v_add_u32 v15, s44, v14
    s_cmp_ge_u32 s41, 28
    s_cbranch_scc1 lw5_nb
    s_barrier
lw5_nb:
    s_mov_b32 s15, 0
lw5_w0:
    s_mov_b32 m0, s14
    s_add_u32 s7, s14, 32768
    buffer_load_dwordx4 v8, s[8:11], s12 offen offset:0 lds
    buffer_load_dwordx4 v9, s[8:11], s12 offen offset:1024 lds
    buffer_load_dwordx4 v10, s[8:11], s12 offen offset:2048 lds
    buffer_load_dwordx4 v11, s[8:11], s12 offen offset:3072 lds
    s_add_u32 m0, s14, 4096
    s_and_b32 s14, s7, 0x1ffff
    buffer_load_dwordx4 v12, s[8:11], s12 offen offset:0 lds
    buffer_load_dwordx4 v13, s[8:11], s12 offen offset:1024 lds
    buffer_load_dwordx4 v14, s[8:11], s12 offen offset:2048 lds
    buffer_load_dwordx4 v15, s[8:11], s12 offen offset:3072 lds
    s_add_u32 s12, s12, s13
    s_add_u32 s15, s15, 1
    s_cmp_lt_u32 s15, 4
    s_cbranch_scc1 lw5_w0
    s_waitcnt vmcnt(24)
    s_barrier
    s_waitcnt vmcnt(16)
    s_barrier
lw5_w1:
    s_waitcnt vmcnt(8)
    s_barrier
    s_mov_b32 m0, s14
    s_add_u32 s7, s14, 32768
    buffer_load_dwordx4 v8, s[8:11], s12 offen offset:0 lds
    buffer_load_dwordx4 v9, s[8:11], s12 offen offset:1024 lds
    buffer_load_dwordx4 v10, s[8:11], s12 offen offset:2048 lds
    buffer_load_dwordx4 v11, s[8:11], s12 offen offset:3072 lds
    s_add_u32 m0, s14, 4096
    s_and_b32 s14, s7, 0x1ffff
    buffer_load_dwordx4 v12, s[8:11], s12 offen offset:0 lds
    buffer_load_dwordx4 v13, s[8:11], s12 offen offset:1024 lds
    buffer_load_dwordx4 v14, s[8:11], s12 offen offset:2048 lds
    buffer_load_dwordx4 v15, s[8:11], s12 offen offset:3072 lds
    s_add_u32 s12, s12, s13
    s_add_u32 s15, s15, 1
    s_cmp_lt_u32 s15, 14
    s_cbranch_scc1 lw5_w1
    s_waitcnt vmcnt(8)
    s_barrier
    s_waitcnt vmcnt(0)
    s_barrier
    s_endpgm
xa1:
    v_mov_b32 v12, 0x3f803f80
    v_mov_b32 v13, v12
    v_mov_b32 v14, v12
    v_mov_b32 v15, v12
    v_lshlrev_b32 v2, 4, v0
    v_add_u32 v2, 122880, v2
    ds_write_b128 v2, v[12:15]
    ds_write_b128 v2, v[12:15] offset:4096
    ds_write_b128 v2, v[12:15] offset:8192
    s_mov_b32 s15, 0
    s_waitcnt lgkmcnt(0)
    s_lshl_b32 s7, s40, 2
    s_add_u32 s7, s7, s3
    s_sub_u32 s7, s7, 8
    s_lshl_b32 s44, s7, 16
    s_lshl_b32 s7, s41, 11
    s_add_u32 s44, s44, s7
    s_add_u32 s45, s44, 2097152
    s_add_u32 s46, s44, 4194304
    s_mov_b32 s36, s32
    s_mov_b32 s37, s33
    s_mov_b32 s38, 6291456
    s_mov_b32 s39, 0x00020000
    v_lshlrev_b32 v16, 4, v1
    s_cmp_lt_u32 s41, 5
    s_cselect_b32 s47, 6, 9
    s_cmp_lg_u32 s3, 8
    s_cbranch_scc1 a1_b
    s_add_u32 s56, s32, 18874368
    s_addc_u32 s57, s33, 0
    s_mov_b32 s58, 327680
    s_mov_b32 s59, 0x00020000
    buffer_load_dword v3, off, s[56:59], 0 sc1
    s_getreg_b32 s7, hwreg(HW_REG_XCC_ID)
    s_and_b32 s7, s7, 15
    s_lshl_b32 s48, s40, 7
    s_add_u32 s48, s48, 4096
    s_lshl_b32 s49, s41, 2
    s_add_u32 s49, s49, s48
    v_and_b32 v4, 31, v1
    v_lshlrev_b32 v4, 2, v4
    s_waitcnt vmcnt(0)
    v_readfirstlane_b32 s60, v3
    s_add_u32 s60, s60, 2654435769
    s_add_u32 s50, s60, 1
    s_add_u32 s61, s50, s7
    v_mov_b32 v3, s61
    s_mov_b64 exec, 1
    buffer_store_dword v3, off, s[56:59], s49 sc1
    s_mov_b64 exec, -1
    s_barrier
    s_barrier
    s_barrier
    s_barrier
    s_mov_b32 s15, 4
    s_mov_b32 s62, 200000
a1_pl:
    buffer_load_dword v3, v4, s[56:59], s48 offen sc1
    s_sub_u32 s62, s62, 1
    s_waitcnt vmcnt(0)
    v_subrev_u32 v5, s50, v3
    v_cmp_lt_u32 vcc, 15, v5
    s_cbranch_scc1 a1_pd
    s_cbranch_vccnz a1_pl
a1_pd:
    v_cmp_ne_u32 vcc, s61, v3
    v_mov_b32 v4, 163584
    v_mov_b32 v6, s60
    s_cmp_eq_u64 vcc, 0
    s_cselect_b32 s7, 1, 0
    v_mov_b32 v7, s7
    ds_write_b64 v4, v[6:7]
    s_waitcnt lgkmcnt(0)
a1_b:
    s_cmp_lg_u32 s15, 6
    s_cbranch_scc1 a1_np
    buffer_load_dwordx4 v[20:23], v16, s[36:39], s44 offen offset:0
    buffer_load_dwordx4 v[20:23], v16, s[36:39], s44 offen offset:1024
a1_np:
    s_cmp_lg_u32 s15, s47
    s_cbranch_scc1 a1_nq
    buffer_load_dwordx4 v[20:23], v16, s[36:39], s45 offen offset:0
    buffer_load_dwordx4 v[20:23], v16, s[36:39], s45 offen offset:1024
    buffer_load_dwordx4 v[20:23], v16, s[36:39], s46 offen offset:0
    buffer_load_dwordx4 v[20:23], v16, s[36:39], s46 offen offset:1024
a1_nq:
    s_barrier
    s_add_u32 s15, s15, 1
    s_cmp_lt_u32 s15, 9
    s_cbranch_scc1 a1_b
    s_waitcnt vmcnt(0)
    v_mov_b32 v2, 163584
    ds_read_b64 v[2:3], v2
    s_add_u32 s56, s32, 18874368
    s_addc_u32 s57, s33, 0
    s_mov_b32 s58, 327680
    s_mov_b32 s59, 0x00020000
    s_waitcnt lgkmcnt(0)
    v_readfirstlane_b32 s60, v2
    v_readfirstlane_b32 s61, v3
    s_lshr_b32 s42, s41, 3
    s_lshl_b32 s7, s40, 2
    s_add_u32 s42, s42, s7
    s_and_b32 s43, s41, 7
    s_lshl_b32 s43, s43, 3
    s_add_u32 s43, s43, s3
    s_sub_u32 s43, s43, 4
    v_lshlrev_b32 v8, 4, v1
    s_lshl_b32 s7, s3, 10
    s_add_u32 s7, s7, 139264
    v_add_u32 v4, s7, v8
    s_mov_b32 s10, 8388608
    s_mov_b32 s11, 0x00020000
    v_and_b32 v2, 15, v1
    v_lshlrev_b32 v2, 4, v2
    v_lshrrev_b32 v3, 5, v1
    v_lshl_or_b32 v2, v3, 8, v2
    v_and_b32 v3, 16, v1
    v_cmp_eq_u32 vcc, 0, v3
    v_mov_b32 v3, 131072
    v_mov_b32 v11, 65536
    v_cndmask_b32 v3, v3, v11, vcc
    v_add_u32 v9, v2, v3
    v_mov_b32 v11, 8192
    v_cndmask_b32 v10, 0, v11, vcc
    s_mov_b32 s15, 8
    s_mov_b32 s47, 0
    s_mov_b32 s49, 7
    s_mov_b32 s48, 0x53800000
    s_mov_b32 s8, s32
    s_mov_b32 s9, s33
    v_mov_b32 v96, 0
    v_mov_b32 v97, 0
    v_mov_b32 v98, 0
    v_mov_b32 v99, 0
    v_mov_b32 v100, 0
    v_mov_b32 v101, 0
    v_mov_b32 v102, 0
    v_mov_b32 v103, 0
    v_mov_b32 v104, 0
    v_mov_b32 v105, 0
    v_mov_b32 v106, 0
    v_mov_b32 v107, 0
    v_mov_b32 v108, 0
    v_mov_b32 v109, 0
    v_mov_b32 v110, 0
    v_mov_b32 v111, 0
    v_mov_b32 v44, 0
    v_mov_b32 v45, 0
    v_mov_b32 v46, 0
    v_mov_b32 v47, 0
    v_mov_b32 v36, 0
    v_mov_b32 v37, 0
    v_mov_b32 v38, 0
    v_mov_b32 v39, 0
    s_lshl_b32 s7, s43, 5
    s_add_u32 s7, s7, s42
    s_lshl_b32 s45, s7, 10
    s_lshl_b32 s53, s7, 6
    s_add_u32 s45, s45, 6291456
    s_add_u32 s53, s53, 65536
    s_branch att
c1:
    s_and_b32 s4, s3, 1
    s_bfe_u32 s5, s3, 0x10001
    s_mov_b32 s34, 0x8000
    v_and_b32 v2, 44, v1
    v_lshlrev_b32 v20, 5, v2
    v_and_b32 v2, 16, v1
    v_lshl_or_b32 v20, v2, 1, v20
    v_and_b32 v2, 2, v1
    v_lshl_or_b32 v20, v2, 2, v20
    v_and_b32 v2, 1, v1
    v_lshl_or_b32 v20, v2, 4, v20
    v_and_b32 v2, 8, v1
    v_lshl_or_b32 v20, v2, 3, v20
    s_lshl_b32 s7, s5, 6
    v_xor_b32 v20, s7, v20
    s_xor_b32 s6, s4, s5
    s_mov_b32 s35, 0x3f803f80
    s_lshl_b32 s7, s6, 12
    v_add_u32 v20, s7, v20
    v_xor_b32 v21, 0x1000, v20
    v_lshrrev_b32 v2, 1, v1
    v_lshrrev_b32 v3, 5, v1
    v_xor_b32 v2, v2, v3
    v_and_b32 v2, 7, v2
    v_and_b32 v3, 31, v1
    v_lshlrev_b32 v3, 7, v3
    v_lshl_or_b32 v2, v2, 4, v3
    s_lshl_b32 s7, s4, 12
    s_lshl_b32 s42, s6, 6
    s_or_b32 s7, s7, s42
    v_xor_b32 v16, s7, v2
    v_xor_b32 v17, 32, v16
    v_xor_b32 v18, 64, v16
    v_xor_b32 v19, 0x60, v16
    v_mov_b32 v22, 0
    v_mov_b32 v23, 0
    v_mov_b32 v24, 0
    v_mov_b32 v25, 0
    v_mov_b32 v26, 0
    v_mov_b32 v27, 0
    v_mov_b32 v64, 0
    v_mov_b32 v65, 0
    v_mov_b32 v66, 0
    v_mov_b32 v67, 0
    v_mov_b32 v68, 0
    v_mov_b32 v69, 0
    v_mov_b32 v70, 0
    v_mov_b32 v71, 0
    v_mov_b32 v72, 0
    v_mov_b32 v73, 0
    v_mov_b32 v74, 0
    v_mov_b32 v75, 0
    v_mov_b32 v76, 0
    v_mov_b32 v77, 0
    v_mov_b32 v78, 0
    v_mov_b32 v79, 0
    v_mov_b32 v80, 0
    v_mov_b32 v81, 0
    v_mov_b32 v82, 0
    v_mov_b32 v83, 0
    v_mov_b32 v84, 0
    v_mov_b32 v85, 0
    v_mov_b32 v86, 0
    v_mov_b32 v87, 0
    v_mov_b32 v88, 0
    v_mov_b32 v89, 0
    v_mov_b32 v90, 0
    v_mov_b32 v91, 0
    v_mov_b32 v92, 0
    v_mov_b32 v93, 0
    v_mov_b32 v94, 0
    v_mov_b32 v95, 0
    v_mov_b32 v96, 0
    v_mov_b32 v97, 0
    v_mov_b32 v98, 0
    v_mov_b32 v99, 0
    v_mov_b32 v100, 0
    v_mov_b32 v101, 0
    v_mov_b32 v102, 0
    v_mov_b32 v103, 0
    v_mov_b32 v104, 0
    v_mov_b32 v105, 0
    v_mov_b32 v106, 0
    v_mov_b32 v107, 0
    v_mov_b32 v108, 0
    v_mov_b32 v109, 0
    v_mov_b32 v110, 0
    v_mov_b32 v111, 0
    v_mov_b32 v112, 0
    v_mov_b32 v113, 0
    v_mov_b32 v114, 0
    v_mov_b32 v115, 0
    v_mov_b32 v116, 0
    v_mov_b32 v117, 0
    v_mov_b32 v118, 0
    v_mov_b32 v119, 0
    v_mov_b32 v120, 0
    v_mov_b32 v121, 0
    v_mov_b32 v122, 0
    v_mov_b32 v123, 0
    v_mov_b32 v124, 0
    v_mov_b32 v125, 0
    v_mov_b32 v126, 0
    v_mov_b32 v127, 0
    v_mov_b32 v128, 0
    v_mov_b32 v129, 0
    v_mov_b32 v130, 0
    v_mov_b32 v131, 0
    v_mov_b32 v132, 0
    v_mov_b32 v133, 0
    v_mov_b32 v134, 0
    v_mov_b32 v135, 0
    v_mov_b32 v136, 0
    v_mov_b32 v137, 0
    v_mov_b32 v138, 0
    v_mov_b32 v139, 0
    v_mov_b32 v140, 0
    v_mov_b32 v141, 0
    v_mov_b32 v142, 0
    v_mov_b32 v143, 0
    s_mov_b32 s15, 0
c1_loop:
    s_barrier
    ds_read_b128 v[32:35], v16
    ds_read_b64_tr_b16 v[36:37], v20 offset:8192
    ds_read_b64_tr_b16 v[38:39], v20 offset:8704
    v_mfma_f32_32x32x16_bf16 v[96:111], v[68:71], v[64:67], v[96:111]
    ds_read_b64_tr_b16 v[40:41], v20 offset:16384
    ds_read_b64_tr_b16 v[42:43], v20 offset:16896
    ds_read_b64_tr_b16 v[44:45], v20 offset:24576
    v_mfma_f32_32x32x16_bf16 v[112:127], v[72:75], v[64:67], v[112:127]
    ds_read_b64_tr_b16 v[46:47], v20 offset:25088
    ds_read_b128 v[48:51], v17
    v_mfma_f32_32x32x16_bf16 v[128:143], v[64:67], v[76:79], v[128:143]
    ds_read_b64_tr_b16 v[52:53], v20 offset:10240
    v_mfma_f32_32x32x16_bf16 v[96:111], v[84:87], v[80:83], v[96:111]
    ds_read_b64_tr_b16 v[54:55], v20 offset:10752
    ds_read_b64_tr_b16 v[56:57], v20 offset:18432
    ds_read_b64_tr_b16 v[58:59], v20 offset:18944
    v_mfma_f32_32x32x16_bf16 v[112:127], v[88:91], v[80:83], v[112:127]
    ds_read_b64_tr_b16 v[60:61], v20 offset:26624
    ds_read_b64_tr_b16 v[62:63], v20 offset:27136
    v_mfma_f32_32x32x16_bf16 v[128:143], v[80:83], v[92:95], v[128:143]
    s_waitcnt lgkmcnt(7)
    v_mfma_f32_32x32x16_bf16 v[96:111], v[36:39], v[32:35], v[96:111]
    ds_read_b128 v[64:67], v18
    ds_read_b64_tr_b16 v[68:69], v21 offset:8192
    ds_read_b64_tr_b16 v[70:71], v21 offset:8704
    v_mfma_f32_32x32x16_bf16 v[112:127], v[40:43], v[32:35], v[112:127]
    ds_read_b64_tr_b16 v[72:73], v21 offset:16384
    ds_read_b64_tr_b16 v[74:75], v21 offset:16896
    v_mfma_f32_32x32x16_bf16 v[128:143], v[32:35], v[44:47], v[128:143]
    ds_read_b64_tr_b16 v[76:77], v21 offset:24576
    ds_read_b64_tr_b16 v[78:79], v21 offset:25088
    v_dot2c_f32_bf16 v22, s35, v32
    v_dot2c_f32_bf16 v23, v32, v32
    v_dot2c_f32_bf16 v24, s35, v36
    v_dot2c_f32_bf16 v25, s35, v40
    v_dot2c_f32_bf16 v26, s35, v44
    v_dot2c_f32_bf16 v22, s35, v33
    v_dot2c_f32_bf16 v23, v33, v33
    v_dot2c_f32_bf16 v24, s35, v37
    v_dot2c_f32_bf16 v25, s35, v41
    v_dot2c_f32_bf16 v26, s35, v45
    v_dot2c_f32_bf16 v22, s35, v34
    v_dot2c_f32_bf16 v23, v34, v34
    v_dot2c_f32_bf16 v24, s35, v38
    v_dot2c_f32_bf16 v25, s35, v42
    v_dot2c_f32_bf16 v26, s35, v46
    v_dot2c_f32_bf16 v22, s35, v35
    v_dot2c_f32_bf16 v23, v35, v35
    v_dot2c_f32_bf16 v24, s35, v39
    v_dot2c_f32_bf16 v25, s35, v43
    v_dot2c_f32_bf16 v26, s35, v47
    s_waitcnt lgkmcnt(7)
    v_mfma_f32_32x32x16_bf16 v[96:111], v[52:55], v[48:51], v[96:111]
    ds_read_b128 v[80:83], v19
    ds_read_b64_tr_b16 v[84:85], v21 offset:10240
    ds_read_b64_tr_b16 v[86:87], v21 offset:10752
    ds_read_b64_tr_b16 v[88:89], v21 offset:18432
    v_mfma_f32_32x32x16_bf16 v[112:127], v[56:59], v[48:51], v[112:127]
    ds_read_b64_tr_b16 v[90:91], v21 offset:18944
    ds_read_b64_tr_b16 v[92:93], v21 offset:26624
    ds_read_b64_tr_b16 v[94:95], v21 offset:27136
    v_mfma_f32_32x32x16_bf16 v[128:143], v[48:51], v[60:63], v[128:143]
    v_xor_b32 v16, s34, v16
    v_xor_b32 v17, s34, v17
    v_xor_b32 v18, s34, v18
    v_xor_b32 v19, s34, v19
    v_xor_b32 v20, s34, v20
    v_xor_b32 v21, s34, v21
    s_xor_b32 s34, s34, 0x10000
    s_add_u32 s15, s15, 1
    s_cmp_lt_u32 s15, 8
    v_dot2c_f32_bf16 v22, s35, v48
    v_dot2c_f32_bf16 v23, v48, v48
    v_dot2c_f32_bf16 v24, s35, v52
    v_dot2c_f32_bf16 v25, s35, v56
    v_dot2c_f32_bf16 v26, s35, v60
    v_dot2c_f32_bf16 v22, s35, v49
    v_dot2c_f32_bf16 v23, v49, v49
    v_dot2c_f32_bf16 v24, s35, v53
    v_dot2c_f32_bf16 v25, s35, v57
    v_dot2c_f32_bf16 v26, s35, v61
    v_dot2c_f32_bf16 v22, s35, v50
    v_dot2c_f32_bf16 v23, v50, v50
    v_dot2c_f32_bf16 v24, s35, v54
    v_dot2c_f32_bf16 v25, s35, v58
    v_dot2c_f32_bf16 v26, s35, v62
    v_dot2c_f32_bf16 v22, s35, v51
    v_dot2c_f32_bf16 v23, v51, v51
    v_dot2c_f32_bf16 v24, s35, v55
    v_dot2c_f32_bf16 v25, s35, v59
    v_dot2c_f32_bf16 v26, s35, v63
    s_waitcnt lgkmcnt(0)
    s_cbranch_scc1 c1_loop
    v_mfma_f32_32x32x16_bf16 v[96:111], v[68:71], v[64:67], v[96:111]
    v_and_b32 v3, 31, v1
    v_lshrrev_b32 v4, 5, v1
    v_lshlrev_b32 v5, 4, v3
    v_lshlrev_b32 v6, 5, v3
    v_permlane32_swap_b32 v22, v23
    v_permlane32_swap_b32 v24, v25
    v_permlane32_swap_b32 v26, v27
    s_lshl_b32 s7, s4, 9
    s_add_u32 s46, s7, 159744
    s_lshl_b32 s7, s5, 10
    s_add_u32 s47, s7, 160768
    v_add_u32 v5, s46, v5
    v_add_u32 v6, s47, v6
    v_mfma_f32_32x32x16_bf16 v[112:127], v[72:75], v[64:67], v[112:127]
    s_lshl_b32 s46, s5, 3
    s_lshl_b32 s47, s4, 4
    v_lshl_add_u32 v7, v4, 2, v5
    v_lshl_add_u32 v8, v4, 2, v6
    v_add_f32 v22, v22, v23
    v_add_f32 v24, v24, v25
    v_add_f32 v26, v26, v27
    v_add_u32 v7, s46, v7
    v_add_u32 v8, s47, v8
    v_mov_b32 v62, 163584
    ds_write_b32 v7, v22
    ds_write_b32 v8, v24
    ds_write_b32 v8, v26 offset:8
    s_waitcnt lgkmcnt(0)
    s_barrier
    ds_read_b128 v[8:11], v5
    ds_read_b128 v[12:15], v6
    ds_read_b128 v[16:19], v6 offset:16
    ds_read_b64 v[62:63], v62
    v_mfma_f32_32x32x16_bf16 v[128:143], v[64:67], v[76:79], v[128:143]
    s_add_u32 s36, s32, 0
    s_addc_u32 s37, s33, 0
    s_mov_b32 s38, 6291456
    s_mov_b32 s39, 0x00020000
    s_lshl_b32 s7, s40, 2
    s_lshl_b32 s48, s5, 1
    s_add_u32 s7, s7, s48
    s_lshl_b32 s54, s7, 7
    s_lshl_b32 s7, s7, 6
    s_lshl_b32 s48, s41, 1
    s_add_u32 s48, s48, s4
    s_add_u32 s7, s7, s48
    s_lshl_b32 s48, s48, 2
    s_add_u32 s54, s54, s48
    s_add_u32 s54, s54, 8192
    s_lshl_b32 s48, s7, 10
    s_add_u32 s49, s48, 0x10000
    s_add_u32 s50, s48, 2097152
    s_add_u32 s51, s48, 2162688
    s_add_u32 s52, s48, 4194304
    s_lshl_b32 s53, s3, 7
    s_add_u32 s53, s53, 162304
    s_add_u32 s56, s32, 18874368
    s_addc_u32 s57, s33, 0
    v_mfma_f32_32x32x16_bf16 v[96:111], v[84:87], v[80:83], v[96:111]
    s_mov_b32 s58, 327680
    s_mov_b32 s59, 0x00020000
    v_lshlrev_b32 v2, 4, v1
    v_and_b32 v7, 16, v1
    v_lshlrev_b32 v7, 12, v7
    v_and_b32 v5, 15, v1
    v_lshl_or_b32 v7, v5, 4, v7
    v_lshl_or_b32 v7, v4, 8, v7
    v_lshl_add_u32 v5, v3, 2, s53
    v_lshl_add_u32 v6, v4, 4, s53
    v_cmp_gt_u32 vcc, 32, v1
    v_mov_b32 v21, 0
    v_mov_b32 v22, 0
    v_mov_b32 v23, 0
    v_mov_b32 v25, 0
    v_mov_b32 v27, 0
    v_mov_b32 v29, 0
    v_mov_b32 v30, 0
    v_mov_b32 v31, 0
    s_waitcnt lgkmcnt(0)
    v_add_f32 v8, v8, v10
    v_add_f32 v10, v9, v11
    v_add_f32 v24, v12, v16
    v_add_f32 v26, v13, v17
    v_add_f32 v28, v14, v18
    v_mfma_f32_32x32x16_bf16 v[112:127], v[88:91], v[80:83], v[112:127]
    v_mul_f32 v8, 0xbb000000, v8
    v_mul_f32 v10, 0x3b000000, v10
    v_fma_f32 v10, -v8, v8, v10
    v_and_b32 v11, 0xffff0000, v8
    v_max_f32 v10, 0, v10
    v_sub_f32 v8, v8, v11
    v_add_f32 v10, 0x3727c5ac, v10
    v_cndmask_b32 v8, v8, v11, vcc
    v_rsq_f32 v9, v10
    v_cvt_pk_bf16_f32 v20, v8, v8
    v_and_b32 v12, 0xffff0000, v24
    v_sub_f32 v24, v24, v12
    v_cvt_pk_bf16_f32 v24, v12, v24
    v_mfma_f32_32x32x16_bf16 v[128:143], v[80:83], v[92:95], v[128:143]
    ds_write_b32 v5, v9
    v_and_b32 v13, 0xffff0000, v26
    v_sub_f32 v26, v26, v13
    v_cvt_pk_bf16_f32 v26, v13, v26
    v_and_b32 v14, 0xffff0000, v28
    v_sub_f32 v28, v28, v14
    v_cvt_pk_bf16_f32 v28, v14, v28
    v_mfma_f32_32x32x16_bf16 v[96:111], v[24:27], v[20:23], v[96:111]
    v_mul_f32 v10, 0x3eb8aa3b, v9
    v_readfirstlane_b32 s60, v62
    v_readfirstlane_b32 s61, v63
    s_waitcnt lgkmcnt(0)
    ds_read_b128 v[32:35], v6 offset:0
    ds_read_b128 v[36:39], v6 offset:32
    ds_read_b128 v[40:43], v6 offset:64
    ds_read_b128 v[44:47], v6 offset:96
    v_mfma_f32_32x32x16_bf16 v[112:127], v[26:29], v[20:23], v[112:127]
    v_mfma_f32_32x32x16_bf16 v[128:143], v[20:23], v[28:31], v[128:143]
    s_nop 3
    v_mov_b32 v12, v9
    v_pk_mul_f32 v[96:97], v[96:97], v[10:11] op_sel_hi:[1,0]
    v_pk_mul_f32 v[98:99], v[98:99], v[10:11] op_sel_hi:[1,0]
    v_pk_mul_f32 v[100:101], v[100:101], v[10:11] op_sel_hi:[1,0]
    v_pk_mul_f32 v[102:103], v[102:103], v[10:11] op_sel_hi:[1,0]
    v_pk_mul_f32 v[104:105], v[104:105], v[10:11] op_sel_hi:[1,0]
    v_pk_mul_f32 v[106:107], v[106:107], v[10:11] op_sel_hi:[1,0]
    v_pk_mul_f32 v[108:109], v[108:109], v[10:11] op_sel_hi:[1,0]
    v_pk_mul_f32 v[110:111], v[110:111], v[10:11] op_sel_hi:[1,0]
    v_cvt_pk_bf16_f32 v48, v96, v97
    v_cvt_pk_bf16_f32 v49, v98, v99
    v_cvt_pk_bf16_f32 v50, v100, v101
    v_cvt_pk_bf16_f32 v51, v102, v103
    v_cvt_pk_bf16_f32 v52, v104, v105
    v_cvt_pk_bf16_f32 v53, v106, v107
    v_cvt_pk_bf16_f32 v54, v108, v109
    v_cvt_pk_bf16_f32 v55, v110, v111
    buffer_store_dwordx4 v[48:51], v2, s[36:39], s48 offen
    buffer_store_dwordx4 v[52:55], v2, s[36:39], s49 offen
    v_pk_mul_f32 v[112:113], v[112:113], v[12:13] op_sel_hi:[1,0]
    v_pk_mul_f32 v[114:115], v[114:115], v[12:13] op_sel_hi:[1,0]
    v_pk_mul_f32 v[116:117], v[116:117], v[12:13] op_sel_hi:[1,0]
    v_pk_mul_f32 v[118:119], v[118:119], v[12:13] op_sel_hi:[1,0]
    v_pk_mul_f32 v[120:121], v[120:121], v[12:13] op_sel_hi:[1,0]
    v_pk_mul_f32 v[122:123], v[122:123], v[12:13] op_sel_hi:[1,0]
    v_pk_mul_f32 v[124:125], v[124:125], v[12:13] op_sel_hi:[1,0]
    v_pk_mul_f32 v[126:127], v[126:127], v[12:13] op_sel_hi:[1,0]
    v_cvt_pk_bf16_f32 v56, v112, v113
    v_cvt_pk_bf16_f32 v57, v114, v115
    v_cvt_pk_bf16_f32 v58, v116, v117
    v_cvt_pk_bf16_f32 v59, v118, v119
    v_cvt_pk_bf16_f32 v60, v120, v121
    v_cvt_pk_bf16_f32 v61, v122, v123
    v_cvt_pk_bf16_f32 v62, v124, v125
    v_cvt_pk_bf16_f32 v63, v126, v127
    buffer_store_dwordx4 v[56:59], v2, s[36:39], s50 offen
    buffer_store_dwordx4 v[60:63], v2, s[36:39], s51 offen
    s_waitcnt lgkmcnt(0)
    v_pk_mul_f32 v[128:129], v[128:129], v[32:33]
    v_pk_mul_f32 v[130:131], v[130:131], v[34:35]
    v_pk_mul_f32 v[132:133], v[132:133], v[36:37]
    v_pk_mul_f32 v[134:135], v[134:135], v[38:39]
    v_pk_mul_f32 v[136:137], v[136:137], v[40:41]
    v_pk_mul_f32 v[138:139], v[138:139], v[42:43]
    v_pk_mul_f32 v[140:141], v[140:141], v[44:45]
    v_pk_mul_f32 v[142:143], v[142:143], v[46:47]
    v_cvt_pk_bf16_f32 v64, v128, v129
    v_cvt_pk_bf16_f32 v65, v130, v131
    v_cvt_pk_bf16_f32 v66, v132, v133
    v_cvt_pk_bf16_f32 v67, v134, v135
    v_cvt_pk_bf16_f32 v68, v136, v137
    v_cvt_pk_bf16_f32 v69, v138, v139
    v_cvt_pk_bf16_f32 v70, v140, v141
    v_cvt_pk_bf16_f32 v71, v142, v143
    buffer_store_dwordx4 v[64:67], v7, s[36:39], s52 offen offset:0
    buffer_store_dwordx4 v[68:71], v7, s[36:39], s52 offen offset:512
    s_lshr_b32 s42, s41, 3
    s_lshl_b32 s7, s40, 2
    s_add_u32 s42, s42, s7
    s_and_b32 s43, s41, 7
    s_and_b32 s4, s3, 1
    s_bfe_u32 s5, s3, 0x10001
    v_lshlrev_b32 v7, 4, v1
    v_and_b32 v2, 31, v1
    v_lshlrev_b32 v6, 10, v2
    v_lshrrev_b32 v2, 5, v1
    v_lshl_or_b32 v6, v2, 4, v6
    s_lshl_b32 s46, s42, 1
    s_add_u32 s46, s46, s4
    s_lshl_b32 s47, s43, 1
    s_add_u32 s47, s47, s5
    s_lshl_b32 s48, s46, 15
    s_lshl_b32 s7, s47, 6
    s_add_u32 s49, s48, s7
    s_lshl_b32 s7, s47, 11
    s_add_u32 s48, s48, s7
    s_mov_b32 s36, s16
    s_mov_b32 s37, s17
    s_mov_b32 s38, 2097152
    s_mov_b32 s39, 0x00020000
    s_mov_b32 s55, s49
    v_mov_b32 v12, v6
    s_lshr_b32 s42, s41, 3
    s_lshl_b32 s7, s40, 2
    s_add_u32 s42, s42, s7
    s_and_b32 s43, s41, 7
    s_lshl_b32 s43, s43, 3
    s_add_u32 s43, s43, s3
    s_sub_u32 s43, s43, 4
    v_lshlrev_b32 v8, 4, v1
    s_lshl_b32 s7, s3, 10
    s_add_u32 s7, s7, 139264
    v_add_u32 v4, s7, v8
    s_mov_b32 s10, 8388608
    s_mov_b32 s11, 0x00020000
    v_and_b32 v2, 15, v1
    v_lshlrev_b32 v2, 4, v2
    v_lshrrev_b32 v3, 5, v1
    v_lshl_or_b32 v2, v3, 8, v2
    v_and_b32 v3, 16, v1
    v_cmp_eq_u32 vcc, 0, v3
    v_mov_b32 v3, 131072
    v_mov_b32 v11, 65536
    v_cndmask_b32 v3, v3, v11, vcc
    v_add_u32 v9, v2, v3
    v_mov_b32 v11, 8192
    v_cndmask_b32 v10, 0, v11, vcc
    s_mov_b32 s15, 8
    s_mov_b32 s47, 0
    s_mov_b32 s49, 7
    s_mov_b32 s48, 0x53800000
    s_mov_b32 s8, s32
    s_mov_b32 s9, s33
    v_mov_b32 v96, 0
    v_mov_b32 v97, 0
    v_mov_b32 v98, 0
    v_mov_b32 v99, 0
    v_mov_b32 v100, 0
    v_mov_b32 v101, 0
    v_mov_b32 v102, 0
    v_mov_b32 v103, 0
    v_mov_b32 v104, 0
    v_mov_b32 v105, 0
    v_mov_b32 v106, 0
    v_mov_b32 v107, 0
    v_mov_b32 v108, 0
    v_mov_b32 v109, 0
    v_mov_b32 v110, 0
    v_mov_b32 v111, 0
    v_mov_b32 v44, 0
    v_mov_b32 v45, 0
    v_mov_b32 v46, 0
    v_mov_b32 v47, 0
    v_mov_b32 v36, 0
    v_mov_b32 v37, 0
    v_mov_b32 v38, 0
    v_mov_b32 v39, 0
    s_lshl_b32 s7, s43, 5
    s_add_u32 s7, s7, s42
    s_lshl_b32 s45, s7, 10
    s_lshl_b32 s53, s7, 6
    s_add_u32 s45, s45, 6291456
    s_add_u32 s53, s53, 65536
    v_mov_b32 v2, s60
    s_cmp_eq_u32 s61, 0
    s_waitcnt vmcnt(0)
    s_cbranch_scc1 c1_slow
    s_mov_b64 exec, 1
    buffer_store_dword v2, off, s[56:59], s54
    s_mov_b64 exec, -1
c1_pb:
    buffer_load_dwordx4 v[160:163], v12, s[36:39], s55 offen offset:0
    buffer_load_dwordx4 v[164:167], v12, s[36:39], s55 offen offset:32
att:
    s_barrier
    ds_read_b128 v[4:7], v4
    ds_read_b128 v[16:19], v8
    ds_read_b128 v[20:23], v8 offset:1024
    ds_read_b128 v[24:27], v9
    ds_read_b128 v[28:31], v9 offset:512
    s_waitcnt lgkmcnt(3)
    v_mfma_f32_32x32x16_bf16 v[64:79], v[16:19], v[4:7], 0
    s_nop 11
    v_max3_f32 v2, v64, v65, v66
    v_max3_f32 v2, v2, v67, v68
    v_max3_f32 v2, v2, v69, v70
    v_max3_f32 v2, v2, v71, v72
    v_max3_f32 v2, v2, v73, v74
    v_max3_f32 v2, v2, v75, v76
    v_max3_f32 v2, v2, v77, v78
    v_max_f32 v2, v2, v79
    v_mov_b32 v3, v2
    s_nop 1
    v_permlane32_swap_b32 v2, v3
    v_max_f32 v2, v2, v3
    v_sub_f32 v80, 0, v2
    v_sub_f32 v81, 0, v2
    v_sub_f32 v82, 0, v2
    v_sub_f32 v83, 0, v2
    v_sub_f32 v84, 0, v2
    v_sub_f32 v85, 0, v2
    v_sub_f32 v86, 0, v2
    v_sub_f32 v87, 0, v2
    v_sub_f32 v88, 0, v2
    v_sub_f32 v89, 0, v2
    v_sub_f32 v90, 0, v2
    v_sub_f32 v91, 0, v2
    v_sub_f32 v92, 0, v2
    v_sub_f32 v93, 0, v2
    v_sub_f32 v94, 0, v2
    v_sub_f32 v95, 0, v2
    s_nop 1
    v_mfma_f32_32x32x16_bf16 v[48:63], v[16:19], v[4:7], v[80:95]
    s_nop 11
att_loop:
    s_cmp_eq_u32 s15, s49
    s_cbranch_scc1 att_sync
att_slot0:
    v_exp_f32 v48, v48
    v_exp_f32 v49, v49
    v_mfma_f32_32x32x16_bf16 v[96:111], v[36:39], v[44:47], v[96:111]
    ds_read_b128 v[32:35], v9 offset:1024
    ds_read_b128 v[36:39], v9 offset:1536
    v_exp_f32 v50, v50
    v_exp_f32 v51, v51
    v_exp_f32 v52, v52
    v_exp_f32 v53, v53
    s_waitcnt lgkmcnt(2)
    v_mfma_f32_32x32x16_bf16 v[64:79], v[20:23], v[4:7], v[80:95]
    ds_read_b128 v[16:19], v8 offset:2048
    v_exp_f32 v54, v54
    v_exp_f32 v55, v55
    v_cvt_pk_bf16_f32 v40, v48, v49
    v_cvt_pk_bf16_f32 v41, v50, v51
    v_cvt_pk_bf16_f32 v42, v52, v53
    v_cvt_pk_bf16_f32 v43, v54, v55
    v_exp_f32 v56, v56
    v_exp_f32 v57, v57
    v_cmp_lt_f32 vcc, s48, v104
    s_cbranch_vccnz att_rare0
att_cont0:
    v_mfma_f32_32x32x16_bf16 v[112:127], v[24:27], v[40:43], v[96:111]
    v_exp_f32 v58, v58
    v_exp_f32 v59, v59
    v_exp_f32 v60, v60
    v_exp_f32 v61, v61
    v_exp_f32 v62, v62
    v_exp_f32 v63, v63
    v_cvt_pk_bf16_f32 v44, v56, v57
    v_cvt_pk_bf16_f32 v45, v58, v59
    v_cvt_pk_bf16_f32 v46, v60, v61
    v_cvt_pk_bf16_f32 v47, v62, v63
    v_exp_f32 v64, v64
    v_exp_f32 v65, v65
    v_mfma_f32_32x32x16_bf16 v[112:127], v[28:31], v[44:47], v[112:127]
    ds_read_b128 v[24:27], v9 offset:2048
    ds_read_b128 v[28:31], v9 offset:2560
    v_exp_f32 v66, v66
    v_exp_f32 v67, v67
    v_exp_f32 v68, v68
    v_exp_f32 v69, v69
    s_waitcnt lgkmcnt(2)
    v_mfma_f32_32x32x16_bf16 v[48:63], v[16:19], v[4:7], v[80:95]
    ds_read_b128 v[20:23], v8 offset:3072
    v_exp_f32 v70, v70
    v_exp_f32 v71, v71
    v_cvt_pk_bf16_f32 v40, v64, v65
    v_cvt_pk_bf16_f32 v41, v66, v67
    v_cvt_pk_bf16_f32 v42, v68, v69
    v_cvt_pk_bf16_f32 v43, v70, v71
    v_exp_f32 v72, v72
    v_exp_f32 v73, v73
    v_mfma_f32_32x32x16_bf16 v[112:127], v[32:35], v[40:43], v[112:127]
    v_exp_f32 v74, v74
    v_exp_f32 v75, v75
    v_exp_f32 v76, v76
    v_exp_f32 v77, v77
    v_exp_f32 v78, v78
    v_exp_f32 v79, v79
    v_cvt_pk_bf16_f32 v44, v72, v73
    v_cvt_pk_bf16_f32 v45, v74, v75
    v_cvt_pk_bf16_f32 v46, v76, v77
    v_cvt_pk_bf16_f32 v47, v78, v79
    v_exp_f32 v48, v48
    v_exp_f32 v49, v49
    v_mfma_f32_32x32x16_bf16 v[112:127], v[36:39], v[44:47], v[112:127]
    ds_read_b128 v[32:35], v9 offset:3072
    ds_read_b128 v[36:39], v9 offset:3584
    v_exp_f32 v50, v50
    v_exp_f32 v51, v51
    v_exp_f32 v52, v52
    v_exp_f32 v53, v53
    s_waitcnt lgkmcnt(2)
    v_mfma_f32_32x32x16_bf16 v[64:79], v[20:23], v[4:7], v[80:95]
    ds_read_b128 v[16:19], v8 offset:4096
    v_exp_f32 v54, v54
    v_exp_f32 v55, v55
    v_cvt_pk_bf16_f32 v40, v48, v49
    v_cvt_pk_bf16_f32 v41, v50, v51
    v_cvt_pk_bf16_f32 v42, v52, v53
    v_cvt_pk_bf16_f32 v43, v54, v55
    v_exp_f32 v56, v56
    v_exp_f32 v57, v57
    v_mfma_f32_32x32x16_bf16 v[112:127], v[24:27], v[40:43], v[112:127]
    v_exp_f32 v58, v58
    v_exp_f32 v59, v59
    v_exp_f32 v60, v60
    v_exp_f32 v61, v61
    v_exp_f32 v62, v62
    v_exp_f32 v63, v63
    v_cvt_pk_bf16_f32 v44, v56, v57
    v_cvt_pk_bf16_f32 v45, v58, v59
    v_cvt_pk_bf16_f32 v46, v60, v61
    v_cvt_pk_bf16_f32 v47, v62, v63
    v_exp_f32 v64, v64
    v_exp_f32 v65, v65
    v_mfma_f32_32x32x16_bf16 v[112:127], v[28:31], v[44:47], v[112:127]
    ds_read_b128 v[24:27], v9 offset:4096
    ds_read_b128 v[28:31], v9 offset:4608
    v_exp_f32 v66, v66
    v_exp_f32 v67, v67
    v_exp_f32 v68, v68
    v_exp_f32 v69, v69
    s_waitcnt lgkmcnt(2)
    v_mfma_f32_32x32x16_bf16 v[48:63], v[16:19], v[4:7], v[80:95]
    ds_read_b128 v[20:23], v8 offset:5120
    v_exp_f32 v70, v70
    v_exp_f32 v71, v71
    v_cvt_pk_bf16_f32 v40, v64, v65
    v_cvt_pk_bf16_f32 v41, v66, v67
    v_cvt_pk_bf16_f32 v42, v68, v69
    v_cvt_pk_bf16_f32 v43, v70, v71
    v_exp_f32 v72, v72
    v_exp_f32 v73, v73
    v_mfma_f32_32x32x16_bf16 v[112:127], v[32:35], v[40:43], v[112:127]
    v_exp_f32 v74, v74
    v_exp_f32 v75, v75
    v_exp_f32 v76, v76
    v_exp_f32 v77, v77
    v_exp_f32 v78, v78
    v_exp_f32 v79, v79
    v_cvt_pk_bf16_f32 v44, v72, v73
    v_cvt_pk_bf16_f32 v45, v74, v75
    v_cvt_pk_bf16_f32 v46, v76, v77
    v_cvt_pk_bf16_f32 v47, v78, v79
att_slot4:
    v_exp_f32 v48, v48
    v_exp_f32 v49, v49
    v_mfma_f32_32x32x16_bf16 v[112:127], v[36:39], v[44:47], v[112:127]
    ds_read_b128 v[32:35], v9 offset:5120
    ds_read_b128 v[36:39], v9 offset:5632
    v_exp_f32 v50, v50
    v_exp_f32 v51, v51
    v_exp_f32 v52, v52
    v_exp_f32 v53, v53
    s_waitcnt lgkmcnt(2)
    v_mfma_f32_32x32x16_bf16 v[64:79], v[20:23], v[4:7], v[80:95]
    ds_read_b128 v[16:19], v8 offset:6144
    v_exp_f32 v54, v54
    v_exp_f32 v55, v55
    v_cvt_pk_bf16_f32 v40, v48, v49
    v_cvt_pk_bf16_f32 v41, v50, v51
    v_cvt_pk_bf16_f32 v42, v52, v53
    v_cvt_pk_bf16_f32 v43, v54, v55
    v_exp_f32 v56, v56
    v_exp_f32 v57, v57
    v_cmp_lt_f32 vcc, s48, v120
    s_cbranch_vccnz att_rare4
att_cont4:
    v_mfma_f32_32x32x16_bf16 v[96:111], v[24:27], v[40:43], v[112:127]
    v_exp_f32 v58, v58
    v_exp_f32 v59, v59
    v_exp_f32 v60, v60
    v_exp_f32 v61, v61
    v_exp_f32 v62, v62
    v_exp_f32 v63, v63
    v_cvt_pk_bf16_f32 v44, v56, v57
    v_cvt_pk_bf16_f32 v45, v58, v59
    v_cvt_pk_bf16_f32 v46, v60, v61
    v_cvt_pk_bf16_f32 v47, v62, v63
    v_exp_f32 v64, v64
    v_exp_f32 v65, v65
    v_mfma_f32_32x32x16_bf16 v[96:111], v[28:31], v[44:47], v[96:111]
    ds_read_b128 v[24:27], v9 offset:6144
    ds_read_b128 v[28:31], v9 offset:6656
    v_exp_f32 v66, v66
    v_exp_f32 v67, v67
    v_exp_f32 v68, v68
    v_exp_f32 v69, v69
    s_waitcnt lgkmcnt(2)
    v_mfma_f32_32x32x16_bf16 v[48:63], v[16:19], v[4:7], v[80:95]
    ds_read_b128 v[20:23], v8 offset:7168
    v_exp_f32 v70, v70
    v_exp_f32 v71, v71
    v_cvt_pk_bf16_f32 v40, v64, v65
    v_cvt_pk_bf16_f32 v41, v66, v67
    v_cvt_pk_bf16_f32 v42, v68, v69
    v_cvt_pk_bf16_f32 v43, v70, v71
    v_exp_f32 v72, v72
    v_exp_f32 v73, v73
    v_mfma_f32_32x32x16_bf16 v[96:111], v[32:35], v[40:43], v[96:111]
    v_exp_f32 v74, v74
    v_exp_f32 v75, v75
    v_exp_f32 v76, v76
    v_exp_f32 v77, v77
    v_exp_f32 v78, v78
    v_exp_f32 v79, v79
    v_cvt_pk_bf16_f32 v44, v72, v73
    v_cvt_pk_bf16_f32 v45, v74, v75
    v_cvt_pk_bf16_f32 v46, v76, v77
    v_cvt_pk_bf16_f32 v47, v78, v79
    v_exp_f32 v48, v48
    v_exp_f32 v49, v49
    v_mfma_f32_32x32x16_bf16 v[96:111], v[36:39], v[44:47], v[96:111]
    ds_read_b128 v[32:35], v9 offset:7168
    ds_read_b128 v[36:39], v9 offset:7680
    v_exp_f32 v50, v50
    v_exp_f32 v51, v51
    v_exp_f32 v52, v52
    v_exp_f32 v53, v53
    s_waitcnt lgkmcnt(2)
    v_mfma_f32_32x32x16_bf16 v[64:79], v[20:23], v[4:7], v[80:95]
    ds_read_b128 v[16:19], v8 offset:8192
    v_exp_f32 v54, v54
    v_exp_f32 v55, v55
    v_cvt_pk_bf16_f32 v40, v48, v49
    v_cvt_pk_bf16_f32 v41, v50, v51
    v_cvt_pk_bf16_f32 v42, v52, v53
    v_cvt_pk_bf16_f32 v43, v54, v55
    v_exp_f32 v56, v56
    v_exp_f32 v57, v57
    v_mfma_f32_32x32x16_bf16 v[96:111], v[24:27], v[40:43], v[96:111]
    v_exp_f32 v58, v58
    v_exp_f32 v59, v59
    v_exp_f32 v60, v60
    v_exp_f32 v61, v61
    v_exp_f32 v62, v62
    v_exp_f32 v63, v63
    v_cvt_pk_bf16_f32 v44, v56, v57
    v_cvt_pk_bf16_f32 v45, v58, v59
    v_cvt_pk_bf16_f32 v46, v60, v61
    v_cvt_pk_bf16_f32 v47, v62, v63
    v_exp_f32 v64, v64
    v_exp_f32 v65, v65
    v_mfma_f32_32x32x16_bf16 v[96:111], v[28:31], v[44:47], v[96:111]
    ds_read_b128 v[24:27], v9 offset:8192
    ds_read_b128 v[28:31], v9 offset:8704
    v_exp_f32 v66, v66
    v_exp_f32 v67, v67
    v_exp_f32 v68, v68
    v_exp_f32 v69, v69
    s_waitcnt lgkmcnt(2)
    v_mfma_f32_32x32x16_bf16 v[48:63], v[16:19], v[4:7], v[80:95]
    ds_read_b128 v[20:23], v8 offset:9216
    v_exp_f32 v70, v70
    v_exp_f32 v71, v71
    v_cvt_pk_bf16_f32 v40, v64, v65
    v_cvt_pk_bf16_f32 v41, v66, v67
    v_cvt_pk_bf16_f32 v42, v68, v69
    v_cvt_pk_bf16_f32 v43, v70, v71
    v_exp_f32 v72, v72
    v_exp_f32 v73, v73
    v_mfma_f32_32x32x16_bf16 v[96:111], v[32:35], v[40:43], v[96:111]
    v_add_u32 v8, 0x2000, v8
    v_add_u32 v9, v10, v9
    v_exp_f32 v74, v74
    v_exp_f32 v75, v75
    v_exp_f32 v76, v76
    v_exp_f32 v77, v77
    v_exp_f32 v78, v78
    v_exp_f32 v79, v79
    s_sub_u32 s15, s15, 1
    s_cmp_lg_u32 s15, 0
    v_cvt_pk_bf16_f32 v44, v72, v73
    v_cvt_pk_bf16_f32 v45, v74, v75
    v_cvt_pk_bf16_f32 v46, v76, v77
    v_cvt_pk_bf16_f32 v47, v78, v79
    s_cbranch_scc1 att_loop
    s_nop 0
    v_mfma_f32_32x32x16_bf16 v[96:111], v[36:39], v[44:47], v[96:111]
    s_mov_b32 s54, s53
    v_lshlrev_b32 v2, 4, v1
    s_nop 9
    v_cmp_lt_f32 vcc, s48, v104
    s_cbranch_vccnz att_rare8
att_cont8:
    v_rcp_f32 v3, v104
    s_nop 0
    v_mul_f32 v96, v96, v3
    v_mul_f32 v97, v97, v3
    v_mul_f32 v98, v98, v3
    v_mul_f32 v99, v99, v3
    v_mul_f32 v100, v100, v3
    v_mul_f32 v101, v101, v3
    v_mul_f32 v102, v102, v3
    v_mul_f32 v103, v103, v3
    v_cvt_pk_bf16_f32 v40, v96, v97
    v_cvt_pk_bf16_f32 v41, v98, v99
    v_cvt_pk_bf16_f32 v42, v100, v101
    v_cvt_pk_bf16_f32 v43, v102, v103
    s_waitcnt vmcnt(0)
    buffer_store_dwordx4 v[40:43], v2, s[8:11], s45 offen sc1
    s_setprio 0
    v_mov_b32 v2, s60
    s_waitcnt vmcnt(0)
    s_mov_b64 exec, 1
    buffer_store_dword v2, off, s[56:59], s54 sc1
    s_mov_b64 exec, -1
    s_waitcnt lgkmcnt(0)
    s_barrier
    s_cmp_lt_u32 s3, 8
    s_cbranch_scc1 c3
    s_endpgm
c3:
    s_lshr_b32 s42, s41, 3
    s_lshl_b32 s7, s40, 2
    s_add_u32 s42, s42, s7
    s_and_b32 s43, s41, 7
    s_and_b32 s4, s3, 1
    s_bfe_u32 s5, s3, 0x10001
    v_lshlrev_b32 v7, 4, v1
    v_and_b32 v2, 31, v1
    v_lshlrev_b32 v6, 10, v2
    v_lshrrev_b32 v2, 5, v1
    v_lshl_or_b32 v6, v2, 4, v6
    s_lshl_b32 s46, s42, 1
    s_add_u32 s46, s46, s4
    s_lshl_b32 s47, s43, 1
    s_add_u32 s47, s47, s5
    s_lshl_b32 s48, s46, 15
    s_lshl_b32 s7, s47, 6
    s_add_u32 s49, s48, s7
    s_lshl_b32 s7, s47, 11
    s_add_u32 s48, s48, s7
    s_mov_b32 s34, 0x8000
    s_lshl_b32 s7, s4, 13
    v_or_b32 v16, s7, v7
    v_and_b32 v2, 44, v1
    v_lshlrev_b32 v17, 5, v2
    v_and_b32 v2, 16, v1
    v_lshl_or_b32 v17, v2, 1, v17
    v_and_b32 v2, 2, v1
    v_lshl_or_b32 v17, v2, 2, v17
    v_and_b32 v2, 1, v1
    v_lshl_or_b32 v17, v2, 4, v17
    v_and_b32 v2, 8, v1
    v_lshl_or_b32 v17, v2, 3, v17
    s_lshl_b32 s7, s5, 6
    v_xor_b32 v17, s7, v17
    s_add_u32 s36, s32, 8388608
    s_addc_u32 s37, s33, 0
    s_mov_b32 s38, 10485760
    s_mov_b32 s39, 0x00020000
    s_lshl_b32 s50, s46, 12
    s_lshr_b32 s7, s47, 2
    s_lshl_b32 s7, s7, 10
    s_add_u32 s50, s50, s7
    s_and_b32 s7, s47, 3
    s_lshl_b32 s7, s7, 2
    s_add_u32 s50, s50, s7
    s_add_u32 s50, s50, 9437184
    s_mov_b32 s35, 0x3f803f80
    v_mov_b32 v2, 0
    v_mov_b32 v3, 0
    s_mov_b32 s15, 0
    v_lshlrev_b32 v96, 16, v160
    v_and_b32 v97, 0xffff0000, v160
    v_lshlrev_b32 v98, 16, v161
    v_and_b32 v99, 0xffff0000, v161
    v_lshlrev_b32 v100, 16, v162
    v_and_b32 v101, 0xffff0000, v162
    v_lshlrev_b32 v102, 16, v163
    v_and_b32 v103, 0xffff0000, v163
    v_lshlrev_b32 v104, 16, v164
    v_and_b32 v105, 0xffff0000, v164
    v_lshlrev_b32 v106, 16, v165
    v_and_b32 v107, 0xffff0000, v165
    v_lshlrev_b32 v108, 16, v166
    v_and_b32 v109, 0xffff0000, v166
    v_lshlrev_b32 v110, 16, v167
    v_and_b32 v111, 0xffff0000, v167
    s_lshl_b32 s54, s46, 6
    s_lshl_b32 s7, s47, 2
    s_add_u32 s54, s54, s7
    s_add_u32 s54, s54, 24576
c3_loop:
    s_barrier
    ds_read_b128 v[32:35], v16 offset:0
    ds_read_b64_tr_b16 v[36:37], v17 offset:16384
    ds_read_b64_tr_b16 v[38:39], v17 offset:16896
    ds_read_b128 v[40:43], v16 offset:1024
    ds_read_b64_tr_b16 v[44:45], v17 offset:18432
    ds_read_b64_tr_b16 v[46:47], v17 offset:18944
    ds_read_b128 v[48:51], v16 offset:2048
    ds_read_b64_tr_b16 v[52:53], v17 offset:20480
    ds_read_b64_tr_b16 v[54:55], v17 offset:20992
    ds_read_b128 v[56:59], v16 offset:3072
    ds_read_b64_tr_b16 v[60:61], v17 offset:22528
    ds_read_b64_tr_b16 v[62:63], v17 offset:23040
    s_waitcnt lgkmcnt(9)
    v_mfma_f32_32x32x16_bf16 v[96:111], v[36:39], v[32:35], v[96:111]
    ds_read_b128 v[64:67], v16 offset:4096
    ds_read_b64_tr_b16 v[68:69], v17 offset:24576
    ds_read_b64_tr_b16 v[70:71], v17 offset:25088
    s_waitcnt lgkmcnt(9)
    v_mfma_f32_32x32x16_bf16 v[96:111], v[44:47], v[40:43], v[96:111]
    ds_read_b128 v[72:75], v16 offset:5120
    ds_read_b64_tr_b16 v[76:77], v17 offset:26624
    ds_read_b64_tr_b16 v[78:79], v17 offset:27136
    s_waitcnt lgkmcnt(9)
    v_mfma_f32_32x32x16_bf16 v[96:111], v[52:55], v[48:51], v[96:111]
    ds_read_b128 v[80:83], v16 offset:6144
    ds_read_b64_tr_b16 v[84:85], v17 offset:28672
    ds_read_b64_tr_b16 v[86:87], v17 offset:29184
    s_waitcnt lgkmcnt(9)
    v_mfma_f32_32x32x16_bf16 v[96:111], v[60:63], v[56:59], v[96:111]
    ds_read_b128 v[88:91], v16 offset:7168
    ds_read_b64_tr_b16 v[92:93], v17 offset:30720
    ds_read_b64_tr_b16 v[94:95], v17 offset:31232
    s_waitcnt lgkmcnt(9)
    v_mfma_f32_32x32x16_bf16 v[96:111], v[68:71], v[64:67], v[96:111]
    v_xor_b32 v16, s34, v16
    v_xor_b32 v17, s34, v17
    s_xor_b32 s34, s34, 0x10000
    s_waitcnt lgkmcnt(6)
    v_mfma_f32_32x32x16_bf16 v[96:111], v[76:79], v[72:75], v[96:111]
    s_add_u32 s15, s15, 1
    s_cmp_lt_u32 s15, 4
    s_waitcnt lgkmcnt(3)
    v_mfma_f32_32x32x16_bf16 v[96:111], v[84:87], v[80:83], v[96:111]
    s_waitcnt lgkmcnt(0)
    v_mfma_f32_32x32x16_bf16 v[96:111], v[92:95], v[88:91], v[96:111]
    s_cbranch_scc1 c3_loop
    s_nop 10
    v_cvt_pk_bf16_f32 v160, v96, v97
    v_cvt_pk_bf16_f32 v161, v98, v99
    v_cvt_pk_bf16_f32 v162, v100, v101
    v_cvt_pk_bf16_f32 v163, v102, v103
    v_cvt_pk_bf16_f32 v164, v104, v105
    v_cvt_pk_bf16_f32 v165, v106, v107
    v_cvt_pk_bf16_f32 v166, v108, v109
    v_cvt_pk_bf16_f32 v167, v110, v111
    buffer_store_dwordx4 v[160:163], v7, s[36:39], s48 offen offset:0
    buffer_store_dwordx4 v[164:167], v7, s[36:39], s48 offen offset:1024
    v_dot2c_f32_bf16 v2, s35, v160
    v_dot2c_f32_bf16 v3, v160, v160
    v_dot2c_f32_bf16 v2, s35, v161
    v_dot2c_f32_bf16 v3, v161, v161
    v_dot2c_f32_bf16 v2, s35, v162
    v_dot2c_f32_bf16 v3, v162, v162
    v_dot2c_f32_bf16 v2, s35, v163
    v_dot2c_f32_bf16 v3, v163, v163
    v_dot2c_f32_bf16 v2, s35, v164
    v_dot2c_f32_bf16 v3, v164, v164
    v_dot2c_f32_bf16 v2, s35, v165
    v_dot2c_f32_bf16 v3, v165, v165
    v_dot2c_f32_bf16 v2, s35, v166
    v_dot2c_f32_bf16 v3, v166, v166
    v_dot2c_f32_bf16 v2, s35, v167
    v_dot2c_f32_bf16 v3, v167, v167
    s_nop 2
    v_permlane32_swap_b32 v2, v3
    v_add_f32 v2, v2, v3
    buffer_store_dword v2, v7, s[36:39], s50 offen
    s_barrier
    s_cmp_ge_u32 s41, 28
    s_cbranch_scc1 c4_skip
    s_and_b32 s4, s3, 1
    s_bfe_u32 s5, s3, 0x10001
    s_mov_b32 s34, 0x8000
    v_and_b32 v2, 44, v1
    v_lshlrev_b32 v20, 5, v2
    v_and_b32 v2, 16, v1
    v_lshl_or_b32 v20, v2, 1, v20
    v_and_b32 v2, 2, v1
    v_lshl_or_b32 v20, v2, 2, v20
    v_and_b32 v2, 1, v1
    v_lshl_or_b32 v20, v2, 4, v20
    v_and_b32 v2, 8, v1
    v_lshl_or_b32 v20, v2, 3, v20
    s_lshl_b32 s7, s5, 6
    v_xor_b32 v20, s7, v20
    s_cmp_ge_u32 s41, 14
    s_cselect_b32 s42, 1, 0
    s_cselect_b32 s7, 14, 0
    s_sub_u32 s43, s41, s7
    s_lshl_b32 s7, s40, 1
    s_add_u32 s42, s42, s7
    v_lshlrev_b32 v8, 4, v1
    s_lshl_b32 s7, s4, 13
    v_or_b32 v16, s7, v8
    v_mov_b32 v64, 0
    v_mov_b32 v65, 0
    v_mov_b32 v66, 0
    v_mov_b32 v67, 0
    v_mov_b32 v68, 0
    v_mov_b32 v69, 0
    v_mov_b32 v70, 0
    v_mov_b32 v71, 0
    v_mov_b32 v72, 0
    v_mov_b32 v73, 0
    v_mov_b32 v74, 0
    v_mov_b32 v75, 0
    v_mov_b32 v76, 0
    v_mov_b32 v77, 0
    v_mov_b32 v78, 0
    v_mov_b32 v79, 0
    v_mov_b32 v80, 0
    v_mov_b32 v81, 0
    v_mov_b32 v82, 0
    v_mov_b32 v83, 0
    v_mov_b32 v84, 0
    v_mov_b32 v85, 0
    v_mov_b32 v86, 0
    v_mov_b32 v87, 0
    v_mov_b32 v88, 0
    v_mov_b32 v89, 0
    v_mov_b32 v90, 0
    v_mov_b32 v91, 0
    v_mov_b32 v92, 0
    v_mov_b32 v93, 0
    v_mov_b32 v94, 0
    v_mov_b32 v95, 0
    v_mov_b32 v96, 0
    v_mov_b32 v97, 0
    v_mov_b32 v98, 0
    v_mov_b32 v99, 0
    v_mov_b32 v100, 0
    v_mov_b32 v101, 0
    v_mov_b32 v102, 0
    v_mov_b32 v103, 0
    v_mov_b32 v104, 0
    v_mov_b32 v105, 0
    v_mov_b32 v106, 0
    v_mov_b32 v107, 0
    v_mov_b32 v108, 0
    v_mov_b32 v109, 0
    v_mov_b32 v110, 0
    v_mov_b32 v111, 0
    v_mov_b32 v112, 0
    v_mov_b32 v113, 0
    v_mov_b32 v114, 0
    v_mov_b32 v115, 0
    v_mov_b32 v116, 0
    v_mov_b32 v117, 0
    v_mov_b32 v118, 0
    v_mov_b32 v119, 0
    v_mov_b32 v120, 0
    v_mov_b32 v121, 0
    v_mov_b32 v122, 0
    v_mov_b32 v123, 0
    v_mov_b32 v124, 0
    v_mov_b32 v125, 0
    v_mov_b32 v126, 0
    v_mov_b32 v127, 0
    v_mov_b32 v128, 0
    v_mov_b32 v129, 0
    v_mov_b32 v130, 0
    v_mov_b32 v131, 0
    v_mov_b32 v132, 0
    v_mov_b32 v133, 0
    v_mov_b32 v134, 0
    v_mov_b32 v135, 0
    v_mov_b32 v136, 0
    v_mov_b32 v137, 0
    v_mov_b32 v138, 0
    v_mov_b32 v139, 0
    v_mov_b32 v140, 0
    v_mov_b32 v141, 0
    v_mov_b32 v142, 0
    v_mov_b32 v143, 0
    v_mov_b32 v144, 0
    v_mov_b32 v145, 0
    v_mov_b32 v146, 0
    v_mov_b32 v147, 0
    v_mov_b32 v148, 0
    v_mov_b32 v149, 0
    v_mov_b32 v150, 0
    v_mov_b32 v151, 0
    v_mov_b32 v152, 0
    v_mov_b32 v153, 0
    v_mov_b32 v154, 0
    v_mov_b32 v155, 0
    v_mov_b32 v156, 0
    v_mov_b32 v157, 0
    v_mov_b32 v158, 0
    v_mov_b32 v159, 0
    s_mov_b32 s15, 0
    v_mov_b32 v2, s60
    s_cmp_eq_u32 s61, 0
    s_waitcnt vmcnt(0)
    s_cbranch_scc1 c3_slow
    s_mov_b64 exec, 1
    buffer_store_dword v2, off, s[56:59], s54
    s_mov_b64 exec, -1
c3_pb:
c4_loop:
    s_barrier
    ds_read_b128 v[32:35], v16 offset:0
    ds_read_b128 v[36:39], v16 offset:4096
    ds_read_b64_tr_b16 v[40:41], v20 offset:16384
    v_mfma_f32_32x32x16_bf16 v[96:111], v[72:75], v[64:67], v[96:111]
    ds_read_b64_tr_b16 v[42:43], v20 offset:16896
    ds_read_b64_tr_b16 v[44:45], v20 offset:24576
    v_mfma_f32_32x32x16_bf16 v[112:127], v[76:79], v[64:67], v[112:127]
    ds_read_b64_tr_b16 v[46:47], v20 offset:25088
    ds_read_b128 v[48:51], v16 offset:1024
    v_mfma_f32_32x32x16_bf16 v[128:143], v[72:75], v[68:71], v[128:143]
    ds_read_b128 v[52:55], v16 offset:5120
    v_mfma_f32_32x32x16_bf16 v[144:159], v[76:79], v[68:71], v[144:159]
    v_mfma_f32_32x32x16_bf16 v[96:111], v[88:91], v[80:83], v[96:111]
    ds_read_b64_tr_b16 v[56:57], v20 offset:18432
    ds_read_b64_tr_b16 v[58:59], v20 offset:18944
    v_mfma_f32_32x32x16_bf16 v[112:127], v[92:95], v[80:83], v[112:127]
    ds_read_b64_tr_b16 v[60:61], v20 offset:26624
    ds_read_b64_tr_b16 v[62:63], v20 offset:27136
    v_mfma_f32_32x32x16_bf16 v[128:143], v[88:91], v[84:87], v[128:143]
    v_mfma_f32_32x32x16_bf16 v[144:159], v[92:95], v[84:87], v[144:159]
    s_waitcnt lgkmcnt(6)
    v_mfma_f32_32x32x16_bf16 v[96:111], v[40:43], v[32:35], v[96:111]
    ds_read_b128 v[64:67], v16 offset:2048
    ds_read_b128 v[68:71], v16 offset:6144
    v_mfma_f32_32x32x16_bf16 v[112:127], v[44:47], v[32:35], v[112:127]
    ds_read_b64_tr_b16 v[72:73], v20 offset:20480
    ds_read_b64_tr_b16 v[74:75], v20 offset:20992
    v_mfma_f32_32x32x16_bf16 v[128:143], v[40:43], v[36:39], v[128:143]
    ds_read_b64_tr_b16 v[76:77], v20 offset:28672
    ds_read_b64_tr_b16 v[78:79], v20 offset:29184
    v_mfma_f32_32x32x16_bf16 v[144:159], v[44:47], v[36:39], v[144:159]
    s_waitcnt lgkmcnt(6)
    v_mfma_f32_32x32x16_bf16 v[96:111], v[56:59], v[48:51], v[96:111]
    ds_read_b128 v[80:83], v16 offset:3072
    ds_read_b128 v[84:87], v16 offset:7168
    ds_read_b64_tr_b16 v[88:89], v20 offset:22528
    v_mfma_f32_32x32x16_bf16 v[112:127], v[60:63], v[48:51], v[112:127]
    ds_read_b64_tr_b16 v[90:91], v20 offset:23040
    ds_read_b64_tr_b16 v[92:93], v20 offset:30720
    ds_read_b64_tr_b16 v[94:95], v20 offset:31232
    v_mfma_f32_32x32x16_bf16 v[128:143], v[56:59], v[52:55], v[128:143]
    v_xor_b32 v16, s34, v16
    v_xor_b32 v20, s34, v20
    s_xor_b32 s34, s34, 0x10000
    s_add_u32 s15, s15, 1
    s_cmp_lt_u32 s15, 8
    v_mfma_f32_32x32x16_bf16 v[144:159], v[60:63], v[52:55], v[144:159]
    s_waitcnt lgkmcnt(0)
    s_cbranch_scc1 c4_loop
    s_barrier
    s_lshl_b32 s7, s4, 11
    s_add_u32 s7, s7, 131072
    v_add_u32 v2, s7, v8
    s_lshl_b32 s7, s5, 10
    s_add_u32 s7, s7, 131080
    v_add_u32 v3, s7, v8
    ds_read_b64 v[10:11], v2
    ds_read_b64 v[12:13], v2 offset:1024
    ds_read_b32 v24, v3
    ds_read_b32 v26, v3 offset:2048
    v_mfma_f32_32x32x16_bf16 v[96:111], v[72:75], v[64:67], v[96:111]
    s_add_u32 s36, s32, 10485760
    s_addc_u32 s37, s33, 0
    s_mov_b32 s38, 7340032
    s_mov_b32 s39, 0x00020000
    s_lshl_b32 s7, s42, 2
    s_lshl_b32 s48, s4, 1
    s_add_u32 s7, s7, s48
    s_lshl_b32 s54, s7, 6
    s_mul_i32 s7, s7, 112
    s_lshl_b32 s48, s43, 3
    s_add_u32 s7, s7, s48
    v_mfma_f32_32x32x16_bf16 v[112:127], v[76:79], v[64:67], v[112:127]
    s_add_u32 s54, s54, s48
    s_lshl_b32 s48, s5, 2
    s_add_u32 s54, s54, s48
    s_add_u32 s54, s54, 32768
    s_lshl_b32 s48, s5, 1
    s_add_u32 s7, s7, s48
    s_lshl_b32 s48, s7, 10
    s_add_u32 s49, s48, 4096
    v_mfma_f32_32x32x16_bf16 v[128:143], v[72:75], v[68:71], v[128:143]
    s_add_u32 s50, s48, 114688
    s_add_u32 s51, s48, 118784
    v_mov_b32 v17, 0
    v_mov_b32 v18, 0
    v_mov_b32 v19, 0
    v_mov_b32 v21, 0
    v_mov_b32 v22, 0
    v_mfma_f32_32x32x16_bf16 v[144:159], v[76:79], v[68:71], v[144:159]
    v_mov_b32 v23, 0
    v_mov_b32 v25, 0
    v_mov_b32 v27, 0
    v_mov_b32 v28, 0
    v_mov_b32 v29, 0
    s_waitcnt lgkmcnt(0)
    v_mov_b32 v16, v10
    v_mov_b32 v20, v12
    v_mov_b32 v10, v11
    v_mov_b32 v12, v13
    v_mfma_f32_32x32x16_bf16 v[96:111], v[88:91], v[80:83], v[96:111]
    v_mfma_f32_32x32x16_bf16 v[96:111], v[24:27], v[16:19], v[96:111]
    v_mfma_f32_32x32x16_bf16 v[112:127], v[92:95], v[80:83], v[112:127]
    v_mfma_f32_32x32x16_bf16 v[112:127], v[26:29], v[16:19], v[112:127]
    v_mfma_f32_32x32x16_bf16 v[128:143], v[88:91], v[84:87], v[128:143]
    v_mul_f32 v96, v96, v10
    v_mul_f32 v97, v97, v10
    v_mul_f32 v98, v98, v10
    v_mul_f32 v99, v99, v10
    v_mul_f32 v100, v100, v10
    v_mul_f32 v101, v101, v10
    v_mul_f32 v102, v102, v10
    v_mul_f32 v103, v103, v10
    v_mul_f32 v104, v104, v10
    v_mfma_f32_32x32x16_bf16 v[128:143], v[24:27], v[20:23], v[128:143]
    v_mul_f32 v105, v105, v10
    v_mul_f32 v106, v106, v10
    v_mul_f32 v107, v107, v10
    v_mul_f32 v108, v108, v10
    v_mul_f32 v109, v109, v10
    v_mul_f32 v110, v110, v10
    v_mul_f32 v111, v111, v10
    v_cvt_pk_bf16_f32 v32, v96, v97
    v_cvt_pk_bf16_f32 v33, v98, v99
    v_mfma_f32_32x32x16_bf16 v[144:159], v[92:95], v[84:87], v[144:159]
    v_cvt_pk_bf16_f32 v34, v100, v101
    v_cvt_pk_bf16_f32 v35, v102, v103
    v_cvt_pk_bf16_f32 v36, v104, v105
    v_cvt_pk_bf16_f32 v37, v106, v107
    v_cvt_pk_bf16_f32 v38, v108, v109
    v_cvt_pk_bf16_f32 v39, v110, v111
    v_pk_max_i16 v32, v32, 0
    v_pk_max_i16 v33, v33, 0
    v_pk_max_i16 v34, v34, 0
    v_mfma_f32_32x32x16_bf16 v[144:159], v[26:29], v[20:23], v[144:159]
    v_pk_max_i16 v35, v35, 0
    v_pk_max_i16 v36, v36, 0
    v_pk_max_i16 v37, v37, 0
    v_pk_max_i16 v38, v38, 0
    v_pk_max_i16 v39, v39, 0
    buffer_store_dwordx4 v[32:35], v8, s[36:39], s48 offen offset:0
    buffer_store_dwordx4 v[36:39], v8, s[36:39], s48 offen offset:1024
    v_mul_f32 v112, v112, v10
    v_mul_f32 v113, v113, v10
    v_mul_f32 v114, v114, v10
    v_mul_f32 v115, v115, v10
    v_mul_f32 v116, v116, v10
    v_mul_f32 v117, v117, v10
    v_mul_f32 v118, v118, v10
    v_mul_f32 v119, v119, v10
    v_mul_f32 v120, v120, v10
    v_mul_f32 v121, v121, v10
    v_mul_f32 v122, v122, v10
    v_mul_f32 v123, v123, v10
    v_mul_f32 v124, v124, v10
    v_mul_f32 v125, v125, v10
    v_mul_f32 v126, v126, v10
    v_mul_f32 v127, v127, v10
    v_cvt_pk_bf16_f32 v40, v112, v113
    v_cvt_pk_bf16_f32 v41, v114, v115
    v_cvt_pk_bf16_f32 v42, v116, v117
    v_cvt_pk_bf16_f32 v43, v118, v119
    v_cvt_pk_bf16_f32 v44, v120, v121
    v_cvt_pk_bf16_f32 v45, v122, v123
    v_cvt_pk_bf16_f32 v46, v124, v125
    v_cvt_pk_bf16_f32 v47, v126, v127
    v_pk_max_i16 v40, v40, 0
    v_pk_max_i16 v41, v41, 0
    v_pk_max_i16 v42, v42, 0
    v_pk_max_i16 v43, v43, 0
    v_pk_max_i16 v44, v44, 0
    v_pk_max_i16 v45, v45, 0
    v_pk_max_i16 v46, v46, 0
    v_pk_max_i16 v47, v47, 0
    buffer_store_dwordx4 v[40:43], v8, s[36:39], s49 offen offset:0
    buffer_store_dwordx4 v[44:47], v8, s[36:39], s49 offen offset:1024
    v_mul_f32 v128, v128, v12
    v_mul_f32 v129, v129, v12
    v_mul_f32 v130, v130, v12
    v_mul_f32 v131, v131, v12
    v_mul_f32 v132, v132, v12
    v_mul_f32 v133, v133, v12
    v_mul_f32 v134, v134, v12
    v_mul_f32 v135, v135, v12
    v_mul_f32 v136, v136, v12
    v_mul_f32 v137, v137, v12
    v_mul_f32 v138, v138, v12
    v_mul_f32 v139, v139, v12
    v_mul_f32 v140, v140, v12
    v_mul_f32 v141, v141, v12
    v_mul_f32 v142, v142, v12
    v_mul_f32 v143, v143, v12
    v_cvt_pk_bf16_f32 v48, v128, v129
    v_cvt_pk_bf16_f32 v49, v130, v131
    v_cvt_pk_bf16_f32 v50, v132, v133
    v_cvt_pk_bf16_f32 v51, v134, v135
    v_cvt_pk_bf16_f32 v52, v136, v137
    v_cvt_pk_bf16_f32 v53, v138, v139
    v_cvt_pk_bf16_f32 v54, v140, v141
    v_cvt_pk_bf16_f32 v55, v142, v143
    v_pk_max_i16 v48, v48, 0
    v_pk_max_i16 v49, v49, 0
    v_pk_max_i16 v50, v50, 0
    v_pk_max_i16 v51, v51, 0
    v_pk_max_i16 v52, v52, 0
    v_pk_max_i16 v53, v53, 0
    v_pk_max_i16 v54, v54, 0
    v_pk_max_i16 v55, v55, 0
    buffer_store_dwordx4 v[48:51], v8, s[36:39], s50 offen offset:0
    buffer_store_dwordx4 v[52:55], v8, s[36:39], s50 offen offset:1024
    v_mul_f32 v144, v144, v12
    v_mul_f32 v145, v145, v12
    v_mul_f32 v146, v146, v12
    v_mul_f32 v147, v147, v12
    v_mul_f32 v148, v148, v12
    v_mul_f32 v149, v149, v12
    v_mul_f32 v150, v150, v12
    v_mul_f32 v151, v151, v12
    v_mul_f32 v152, v152, v12
    v_mul_f32 v153, v153, v12
    v_mul_f32 v154, v154, v12
    v_mul_f32 v155, v155, v12
    v_mul_f32 v156, v156, v12
    v_mul_f32 v157, v157, v12
    v_mul_f32 v158, v158, v12
    v_mul_f32 v159, v159, v12
    v_cvt_pk_bf16_f32 v56, v144, v145
    v_cvt_pk_bf16_f32 v57, v146, v147
    v_cvt_pk_bf16_f32 v58, v148, v149
    v_cvt_pk_bf16_f32 v59, v150, v151
    v_cvt_pk_bf16_f32 v60, v152, v153
    v_cvt_pk_bf16_f32 v61, v154, v155
    v_cvt_pk_bf16_f32 v62, v156, v157
    v_cvt_pk_bf16_f32 v63, v158, v159
    v_pk_max_i16 v56, v56, 0
    v_pk_max_i16 v57, v57, 0
    v_pk_max_i16 v58, v58, 0
    v_pk_max_i16 v59, v59, 0
    v_pk_max_i16 v60, v60, 0
    v_pk_max_i16 v61, v61, 0
    v_pk_max_i16 v62, v62, 0
    v_pk_max_i16 v63, v63, 0
    buffer_store_dwordx4 v[56:59], v8, s[36:39], s51 offen offset:0
    buffer_store_dwordx4 v[60:63], v8, s[36:39], s51 offen offset:1024
    s_barrier
c5:
    s_lshr_b32 s42, s41, 3
    s_lshl_b32 s7, s40, 2
    s_add_u32 s42, s42, s7
    s_and_b32 s43, s41, 7
    s_and_b32 s4, s3, 1
    s_bfe_u32 s5, s3, 0x10001
    v_lshlrev_b32 v7, 4, v1
    v_and_b32 v2, 31, v1
    v_lshlrev_b32 v6, 10, v2
    v_lshrrev_b32 v2, 5, v1
    v_lshl_or_b32 v6, v2, 4, v6
    s_lshl_b32 s46, s42, 1
    s_add_u32 s46, s46, s4
    s_lshl_b32 s47, s43, 1
    s_add_u32 s47, s47, s5
    s_lshl_b32 s48, s46, 15
    s_lshl_b32 s7, s47, 6
    s_add_u32 s49, s48, s7
    s_lshl_b32 s7, s47, 11
    s_add_u32 s48, s48, s7
    s_mov_b32 s34, 0x8000
    s_lshl_b32 s7, s4, 13
    v_or_b32 v16, s7, v7
    v_and_b32 v2, 44, v1
    v_lshlrev_b32 v17, 5, v2
    v_and_b32 v2, 16, v1
    v_lshl_or_b32 v17, v2, 1, v17
    v_and_b32 v2, 2, v1
    v_lshl_or_b32 v17, v2, 2, v17
    v_and_b32 v2, 1, v1
    v_lshl_or_b32 v17, v2, 4, v17
    v_and_b32 v2, 8, v1
    v_lshl_or_b32 v17, v2, 3, v17
    s_lshl_b32 s7, s5, 6
    v_xor_b32 v17, s7, v17
    s_mov_b32 s36, s28
    s_mov_b32 s37, s29
    s_mov_b32 s38, 2097152
    s_mov_b32 s39, 0x00020000
    s_mov_b32 s15, 0
    v_lshlrev_b32 v96, 16, v160
    v_and_b32 v97, 0xffff0000, v160
    v_lshlrev_b32 v98, 16, v161
    v_and_b32 v99, 0xffff0000, v161
    v_lshlrev_b32 v100, 16, v162
    v_and_b32 v101, 0xffff0000, v162
    v_lshlrev_b32 v102, 16, v163
    v_and_b32 v103, 0xffff0000, v163
    v_lshlrev_b32 v104, 16, v164
    v_and_b32 v105, 0xffff0000, v164
    v_lshlrev_b32 v106, 16, v165
    v_and_b32 v107, 0xffff0000, v165
    v_lshlrev_b32 v108, 16, v166
    v_and_b32 v109, 0xffff0000, v166
    v_lshlrev_b32 v110, 16, v167
    v_and_b32 v111, 0xffff0000, v167
    s_cmp_ge_u32 s41, 28
    s_cbranch_scc1 c5_np
    v_mov_b32 v4, s60
    s_cmp_eq_u32 s61, 0
    s_waitcnt vmcnt(0)
    s_cbranch_scc1 c4_slow
    s_mov_b64 exec, 1
    buffer_store_dword v4, off, s[56:59], s54
    s_mov_b64 exec, -1
c4_pb:
c5_np:
c5_loop:
    s_barrier
    ds_read_b128 v[32:35], v16 offset:0
    ds_read_b64_tr_b16 v[36:37], v17 offset:16384
    ds_read_b64_tr_b16 v[38:39], v17 offset:16896
    ds_read_b128 v[40:43], v16 offset:1024
    ds_read_b64_tr_b16 v[44:45], v17 offset:18432
    ds_read_b64_tr_b16 v[46:47], v17 offset:18944
    ds_read_b128 v[48:51], v16 offset:2048
    ds_read_b64_tr_b16 v[52:53], v17 offset:20480
    ds_read_b64_tr_b16 v[54:55], v17 offset:20992
    ds_read_b128 v[56:59], v16 offset:3072
    ds_read_b64_tr_b16 v[60:61], v17 offset:22528
    ds_read_b64_tr_b16 v[62:63], v17 offset:23040
    s_waitcnt lgkmcnt(9)
    v_mfma_f32_32x32x16_bf16 v[96:111], v[36:39], v[32:35], v[96:111]
    ds_read_b128 v[64:67], v16 offset:4096
    ds_read_b64_tr_b16 v[68:69], v17 offset:24576
    ds_read_b64_tr_b16 v[70:71], v17 offset:25088
    s_waitcnt lgkmcnt(9)
    v_mfma_f32_32x32x16_bf16 v[96:111], v[44:47], v[40:43], v[96:111]
    ds_read_b128 v[72:75], v16 offset:5120
    ds_read_b64_tr_b16 v[76:77], v17 offset:26624
    ds_read_b64_tr_b16 v[78:79], v17 offset:27136
    s_waitcnt lgkmcnt(9)
    v_mfma_f32_32x32x16_bf16 v[96:111], v[52:55], v[48:51], v[96:111]
    ds_read_b128 v[80:83], v16 offset:6144
    ds_read_b64_tr_b16 v[84:85], v17 offset:28672
    ds_read_b64_tr_b16 v[86:87], v17 offset:29184
    s_waitcnt lgkmcnt(9)
    v_mfma_f32_32x32x16_bf16 v[96:111], v[60:63], v[56:59], v[96:111]
    ds_read_b128 v[88:91], v16 offset:7168
    ds_read_b64_tr_b16 v[92:93], v17 offset:30720
    ds_read_b64_tr_b16 v[94:95], v17 offset:31232
    s_waitcnt lgkmcnt(9)
    v_mfma_f32_32x32x16_bf16 v[96:111], v[68:71], v[64:67], v[96:111]
    v_xor_b32 v16, s34, v16
    v_xor_b32 v17, s34, v17
    s_xor_b32 s34, s34, 0x10000
    s_waitcnt lgkmcnt(6)
    v_mfma_f32_32x32x16_bf16 v[96:111], v[76:79], v[72:75], v[96:111]
    s_add_u32 s15, s15, 1
    s_cmp_lt_u32 s15, 14
    s_waitcnt lgkmcnt(3)
    v_mfma_f32_32x32x16_bf16 v[96:111], v[84:87], v[80:83], v[96:111]
    s_waitcnt lgkmcnt(0)
    v_mfma_f32_32x32x16_bf16 v[96:111], v[92:95], v[88:91], v[96:111]
    s_cbranch_scc1 c5_loop
    s_nop 10
    v_cvt_pk_bf16_f32 v160, v96, v97
    v_cvt_pk_bf16_f32 v161, v98, v99
    v_cvt_pk_bf16_f32 v162, v100, v101
    v_cvt_pk_bf16_f32 v163, v102, v103
    v_cvt_pk_bf16_f32 v164, v104, v105
    v_cvt_pk_bf16_f32 v165, v106, v107
    v_cvt_pk_bf16_f32 v166, v108, v109
    v_cvt_pk_bf16_f32 v167, v110, v111
    buffer_store_dwordx4 v[160:163], v6, s[36:39], s49 offen offset:0
    buffer_store_dwordx4 v[164:167], v6, s[36:39], s49 offen offset:32
    s_endpgm
c4_skip:
    v_mov_b32 v2, s60
    s_cmp_eq_u32 s61, 0
    s_waitcnt vmcnt(0)
    s_cbranch_scc1 c3s_slow
    s_mov_b64 exec, 1
    buffer_store_dword v2, off, s[56:59], s54
    s_mov_b64 exec, -1
c3s_pb:
    s_mov_b32 s36, s26
    s_mov_b32 s37, s27
    s_mov_b32 s38, 1835008
    s_mov_b32 s39, 0x00020000
    s_sub_u32 s7, s41, 28
    s_lshl_b32 s7, s7, 2
    s_add_u32 s7, s7, s3
    s_sub_u32 s7, s7, 4
    s_lshl_b32 s50, s7, 10
    s_mov_b32 s15, 0
    v_lshlrev_b32 v2, 4, v1
c4_pf:
    buffer_load_dwordx4 v[8:11], v2, s[36:39], s50 offen
    s_add_u32 s50, s50, 16384
    buffer_load_dwordx4 v[8:11], v2, s[36:39], s50 offen
    s_add_u32 s50, s50, 16384
    buffer_load_dwordx4 v[8:11], v2, s[36:39], s50 offen
    s_add_u32 s50, s50, 16384
    buffer_load_dwordx4 v[8:11], v2, s[36:39], s50 offen
    s_add_u32 s50, s50, 16384
    s_add_u32 s15, s15, 1
    s_cmp_lt_u32 s15, 28
    s_waitcnt vmcnt(24)
    s_cbranch_scc1 c4_pf
    s_waitcnt vmcnt(0)
    s_branch c5
l2_inv:
    buffer_inv sc1
    s_waitcnt vmcnt(0)
    s_branch l2_ib
lx3_ep:
    v_mov_b32 v6, s60
    s_mov_b64 exec, 1
    buffer_store_dword v6, off, s[56:59], 0
    s_mov_b64 exec, -1
    s_waitcnt vmcnt(0)
    s_branch lx3_eb
lx4_inv:
    buffer_inv sc1
    s_waitcnt vmcnt(0)
    s_branch lx4_ib
lx5_inv:
    buffer_inv sc1
    s_waitcnt vmcnt(0)
    s_branch lx5_ib
c1_slow:
    buffer_wbl2 sc1
    s_waitcnt vmcnt(0)
    s_mov_b64 exec, 1
    buffer_store_dword v2, off, s[56:59], s54 sc1
    s_mov_b64 exec, -1
    s_branch c1_pb
att_sync:
    s_cmp_lt_u32 s49, 6
    s_cbranch_scc1 att_sy0
    s_barrier
    s_cmp_eq_u32 s49, 6
    s_cbranch_scc1 att_sy6
    s_mov_b32 s49, 6
    s_cmp_lt_u32 s3, 8
    s_cbranch_scc1 att_slot0
    s_setprio 1
    s_branch att_slot0
att_sy6:
    s_cmp_lt_u32 s3, 8
    s_cselect_b32 s49, -1, 1
    s_branch att_slot0
att_sy0:
    s_setprio 0
    s_mov_b32 s49, -1
    s_branch att_slot0
att_rare0:
    s_add_u32 s47, s47, 1
    s_cmp_gt_u32 s47, 64
    s_cbranch_scc1 att_cont0
    v_subrev_u32 v8, 0x2000, v8
    v_sub_u32 v9, v9, v10
    s_add_u32 s15, s15, 1
    s_waitcnt lgkmcnt(0)
    s_nop 11
    ds_read_b128 v[16:19], v8 offset:4096
    s_waitcnt lgkmcnt(0)
    v_mfma_f32_32x32x16_bf16 v[48:63], v[16:19], v[4:7], v[80:95]
    s_nop 11
    v_max3_f32 v2, v48, v49, v50
    v_max3_f32 v2, v2, v51, v52
    v_max3_f32 v2, v2, v53, v54
    v_max3_f32 v2, v2, v55, v56
    v_max3_f32 v2, v2, v57, v58
    v_max3_f32 v2, v2, v59, v60
    v_max3_f32 v2, v2, v61, v62
    v_max_f32 v2, v2, v63
    ds_read_b128 v[16:19], v8 offset:5120
    s_waitcnt lgkmcnt(0)
    v_mfma_f32_32x32x16_bf16 v[48:63], v[16:19], v[4:7], v[80:95]
    s_nop 11
    v_max3_f32 v2, v2, v48, v49
    v_max3_f32 v2, v2, v50, v51
    v_max3_f32 v2, v2, v52, v53
    v_max3_f32 v2, v2, v54, v55
    v_max3_f32 v2, v2, v56, v57
    v_max3_f32 v2, v2, v58, v59
    v_max3_f32 v2, v2, v60, v61
    v_max3_f32 v2, v2, v62, v63
    ds_read_b128 v[16:19], v8 offset:6144
    s_waitcnt lgkmcnt(0)
    v_mfma_f32_32x32x16_bf16 v[48:63], v[16:19], v[4:7], v[80:95]
    s_nop 11
    v_max3_f32 v2, v2, v48, v49
    v_max3_f32 v2, v2, v50, v51
    v_max3_f32 v2, v2, v52, v53
    v_max3_f32 v2, v2, v54, v55
    v_max3_f32 v2, v2, v56, v57
    v_max3_f32 v2, v2, v58, v59
    v_max3_f32 v2, v2, v60, v61
    v_max3_f32 v2, v2, v62, v63
    ds_read_b128 v[16:19], v8 offset:7168
    s_waitcnt lgkmcnt(0)
    v_mfma_f32_32x32x16_bf16 v[48:63], v[16:19], v[4:7], v[80:95]
    s_nop 11
    v_max3_f32 v2, v2, v48, v49
    v_max3_f32 v2, v2, v50, v51
    v_max3_f32 v2, v2, v52, v53
    v_max3_f32 v2, v2, v54, v55
    v_max3_f32 v2, v2, v56, v57
    v_max3_f32 v2, v2, v58, v59
    v_max3_f32 v2, v2, v60, v61
    v_max3_f32 v2, v2, v62, v63
    v_mov_b32 v3, v2
    s_nop 1
    v_permlane32_swap_b32 v2, v3
    v_max3_f32 v2, v2, v3, 0
    v_sub_f32 v3, 0, v2
    v_exp_f32 v3, v3
    ds_read_b128 v[16:19], v8 offset:4096
    ds_read_b128 v[20:23], v8 offset:5120
    ds_read_b128 v[24:27], v9 offset:4096
    ds_read_b128 v[28:31], v9 offset:4608
    v_mul_f32 v112, v112, v3
    v_sub_f32 v80, v80, v2
    v_mul_f32 v113, v113, v3
    v_sub_f32 v81, v81, v2
    v_mul_f32 v114, v114, v3
    v_sub_f32 v82, v82, v2
    v_mul_f32 v115, v115, v3
    v_sub_f32 v83, v83, v2
    v_mul_f32 v116, v116, v3
    v_sub_f32 v84, v84, v2
    v_mul_f32 v117, v117, v3
    v_sub_f32 v85, v85, v2
    v_mul_f32 v118, v118, v3
    v_sub_f32 v86, v86, v2
    v_mul_f32 v119, v119, v3
    v_sub_f32 v87, v87, v2
    v_mul_f32 v120, v120, v3
    v_sub_f32 v88, v88, v2
    v_mul_f32 v121, v121, v3
    v_sub_f32 v89, v89, v2
    v_mul_f32 v122, v122, v3
    v_sub_f32 v90, v90, v2
    v_mul_f32 v123, v123, v3
    v_sub_f32 v91, v91, v2
    v_mul_f32 v124, v124, v3
    v_sub_f32 v92, v92, v2
    v_mul_f32 v125, v125, v3
    v_sub_f32 v93, v93, v2
    v_mul_f32 v126, v126, v3
    v_sub_f32 v94, v94, v2
    v_mul_f32 v127, v127, v3
    v_sub_f32 v95, v95, v2
    v_mov_b32 v44, 0
    v_mov_b32 v45, 0
    v_mov_b32 v46, 0
    v_mov_b32 v47, 0
    s_waitcnt lgkmcnt(0)
    v_mfma_f32_32x32x16_bf16 v[48:63], v[16:19], v[4:7], v[80:95]
    s_nop 11
    s_branch att_slot4
att_rare4:
    s_add_u32 s47, s47, 1
    s_cmp_gt_u32 s47, 64
    s_cbranch_scc1 att_cont4
    s_waitcnt lgkmcnt(0)
    s_nop 11
    ds_read_b128 v[16:19], v8 offset:0
    s_waitcnt lgkmcnt(0)
    v_mfma_f32_32x32x16_bf16 v[48:63], v[16:19], v[4:7], v[80:95]
    s_nop 11
    v_max3_f32 v2, v48, v49, v50
    v_max3_f32 v2, v2, v51, v52
    v_max3_f32 v2, v2, v53, v54
    v_max3_f32 v2, v2, v55, v56
    v_max3_f32 v2, v2, v57, v58
    v_max3_f32 v2, v2, v59, v60
    v_max3_f32 v2, v2, v61, v62
    v_max_f32 v2, v2, v63
    ds_read_b128 v[16:19], v8 offset:1024
    s_waitcnt lgkmcnt(0)
    v_mfma_f32_32x32x16_bf16 v[48:63], v[16:19], v[4:7], v[80:95]
    s_nop 11
    v_max3_f32 v2, v2, v48, v49
    v_max3_f32 v2, v2, v50, v51
    v_max3_f32 v2, v2, v52, v53
    v_max3_f32 v2, v2, v54, v55
    v_max3_f32 v2, v2, v56, v57
    v_max3_f32 v2, v2, v58, v59
    v_max3_f32 v2, v2, v60, v61
    v_max3_f32 v2, v2, v62, v63
    ds_read_b128 v[16:19], v8 offset:2048
    s_waitcnt lgkmcnt(0)
    v_mfma_f32_32x32x16_bf16 v[48:63], v[16:19], v[4:7], v[80:95]
    s_nop 11
    v_max3_f32 v2, v2, v48, v49
    v_max3_f32 v2, v2, v50, v51
    v_max3_f32 v2, v2, v52, v53
    v_max3_f32 v2, v2, v54, v55
    v_max3_f32 v2, v2, v56, v57
    v_max3_f32 v2, v2, v58, v59
    v_max3_f32 v2, v2, v60, v61
    v_max3_f32 v2, v2, v62, v63
    ds_read_b128 v[16:19], v8 offset:3072
    s_waitcnt lgkmcnt(0)
    v_mfma_f32_32x32x16_bf16 v[48:63], v[16:19], v[4:7], v[80:95]
    s_nop 11
    v_max3_f32 v2, v2, v48, v49
    v_max3_f32 v2, v2, v50, v51
    v_max3_f32 v2, v2, v52, v53
    v_max3_f32 v2, v2, v54, v55
    v_max3_f32 v2, v2, v56, v57
    v_max3_f32 v2, v2, v58, v59
    v_max3_f32 v2, v2, v60, v61
    v_max3_f32 v2, v2, v62, v63
    v_mov_b32 v3, v2
    s_nop 1
    v_permlane32_swap_b32 v2, v3
    v_max3_f32 v2, v2, v3, 0
    v_sub_f32 v3, 0, v2
    v_exp_f32 v3, v3
    ds_read_b128 v[16:19], v8 offset:0
    ds_read_b128 v[20:23], v8 offset:1024
    ds_read_b128 v[24:27], v9 offset:0
    ds_read_b128 v[28:31], v9 offset:512
    v_mul_f32 v96, v96, v3
    v_sub_f32 v80, v80, v2
    v_mul_f32 v97, v97, v3
    v_sub_f32 v81, v81, v2
    v_mul_f32 v98, v98, v3
    v_sub_f32 v82, v82, v2
    v_mul_f32 v99, v99, v3
    v_sub_f32 v83, v83, v2
    v_mul_f32 v100, v100, v3
    v_sub_f32 v84, v84, v2
    v_mul_f32 v101, v101, v3
    v_sub_f32 v85, v85, v2
    v_mul_f32 v102, v102, v3
    v_sub_f32 v86, v86, v2
    v_mul_f32 v103, v103, v3
    v_sub_f32 v87, v87, v2
    v_mul_f32 v104, v104, v3
    v_sub_f32 v88, v88, v2
    v_mul_f32 v105, v105, v3
    v_sub_f32 v89, v89, v2
    v_mul_f32 v106, v106, v3
    v_sub_f32 v90, v90, v2
    v_mul_f32 v107, v107, v3
    v_sub_f32 v91, v91, v2
    v_mul_f32 v108, v108, v3
    v_sub_f32 v92, v92, v2
    v_mul_f32 v109, v109, v3
    v_sub_f32 v93, v93, v2
    v_mul_f32 v110, v110, v3
    v_sub_f32 v94, v94, v2
    v_mul_f32 v111, v111, v3
    v_sub_f32 v95, v95, v2
    v_mov_b32 v44, 0
    v_mov_b32 v45, 0
    v_mov_b32 v46, 0
    v_mov_b32 v47, 0
    s_waitcnt lgkmcnt(0)
    v_mfma_f32_32x32x16_bf16 v[48:63], v[16:19], v[4:7], v[80:95]
    s_nop 11
    s_branch att_slot0
att_rare8:
    s_add_u32 s47, s47, 1
    s_cmp_gt_u32 s47, 64
    s_cbranch_scc1 att_cont8
    v_subrev_u32 v8, 0x2000, v8
    v_sub_u32 v9, v9, v10
    s_add_u32 s15, s15, 1
    s_waitcnt lgkmcnt(0)
    s_nop 11
    ds_read_b128 v[16:19], v8 offset:4096
    s_waitcnt lgkmcnt(0)
    v_mfma_f32_32x32x16_bf16 v[48:63], v[16:19], v[4:7], v[80:95]
    s_nop 11
    v_max3_f32 v2, v48, v49, v50
    v_max3_f32 v2, v2, v51, v52
    v_max3_f32 v2, v2, v53, v54
    v_max3_f32 v2, v2, v55, v56
    v_max3_f32 v2, v2, v57, v58
    v_max3_f32 v2, v2, v59, v60
    v_max3_f32 v2, v2, v61, v62
    v_max_f32 v2, v2, v63
    ds_read_b128 v[16:19], v8 offset:5120
    s_waitcnt lgkmcnt(0)
    v_mfma_f32_32x32x16_bf16 v[48:63], v[16:19], v[4:7], v[80:95]
    s_nop 11
    v_max3_f32 v2, v2, v48, v49
    v_max3_f32 v2, v2, v50, v51
    v_max3_f32 v2, v2, v52, v53
    v_max3_f32 v2, v2, v54, v55
    v_max3_f32 v2, v2, v56, v57
    v_max3_f32 v2, v2, v58, v59
    v_max3_f32 v2, v2, v60, v61
    v_max3_f32 v2, v2, v62, v63
    ds_read_b128 v[16:19], v8 offset:6144
    s_waitcnt lgkmcnt(0)
    v_mfma_f32_32x32x16_bf16 v[48:63], v[16:19], v[4:7], v[80:95]
    s_nop 11
    v_max3_f32 v2, v2, v48, v49
    v_max3_f32 v2, v2, v50, v51
    v_max3_f32 v2, v2, v52, v53
    v_max3_f32 v2, v2, v54, v55
    v_max3_f32 v2, v2, v56, v57
    v_max3_f32 v2, v2, v58, v59
    v_max3_f32 v2, v2, v60, v61
    v_max3_f32 v2, v2, v62, v63
    ds_read_b128 v[16:19], v8 offset:7168
    s_waitcnt lgkmcnt(0)
    v_mfma_f32_32x32x16_bf16 v[48:63], v[16:19], v[4:7], v[80:95]
    s_nop 11
    v_max3_f32 v2, v2, v48, v49
    v_max3_f32 v2, v2, v50, v51
    v_max3_f32 v2, v2, v52, v53
    v_max3_f32 v2, v2, v54, v55
    v_max3_f32 v2, v2, v56, v57
    v_max3_f32 v2, v2, v58, v59
    v_max3_f32 v2, v2, v60, v61
    v_max3_f32 v2, v2, v62, v63
    v_mov_b32 v3, v2
    s_nop 1
    v_permlane32_swap_b32 v2, v3
    v_max3_f32 v2, v2, v3, 0
    v_sub_f32 v3, 0, v2
    v_exp_f32 v3, v3
    ds_read_b128 v[16:19], v8 offset:4096
    ds_read_b128 v[20:23], v8 offset:5120
    ds_read_b128 v[24:27], v9 offset:4096
    ds_read_b128 v[28:31], v9 offset:4608
    v_mul_f32 v112, v112, v3
    v_sub_f32 v80, v80, v2
    v_mul_f32 v113, v113, v3
    v_sub_f32 v81, v81, v2
    v_mul_f32 v114, v114, v3
    v_sub_f32 v82, v82, v2
    v_mul_f32 v115, v115, v3
    v_sub_f32 v83, v83, v2
    v_mul_f32 v116, v116, v3
    v_sub_f32 v84, v84, v2
    v_mul_f32 v117, v117, v3
    v_sub_f32 v85, v85, v2
    v_mul_f32 v118, v118, v3
    v_sub_f32 v86, v86, v2
    v_mul_f32 v119, v119, v3
    v_sub_f32 v87, v87, v2
    v_mul_f32 v120, v120, v3
    v_sub_f32 v88, v88, v2
    v_mul_f32 v121, v121, v3
    v_sub_f32 v89, v89, v2
    v_mul_f32 v122, v122, v3
    v_sub_f32 v90, v90, v2
    v_mul_f32 v123, v123, v3
    v_sub_f32 v91, v91, v2
    v_mul_f32 v124, v124, v3
    v_sub_f32 v92, v92, v2
    v_mul_f32 v125, v125, v3
    v_sub_f32 v93, v93, v2
    v_mul_f32 v126, v126, v3
    v_sub_f32 v94, v94, v2
    v_mul_f32 v127, v127, v3
    v_sub_f32 v95, v95, v2
    v_mov_b32 v44, 0
    v_mov_b32 v45, 0
    v_mov_b32 v46, 0
    v_mov_b32 v47, 0
    s_waitcnt lgkmcnt(0)
    v_mfma_f32_32x32x16_bf16 v[48:63], v[16:19], v[4:7], v[80:95]
    s_nop 11
    s_branch att_slot4
c3_slow:
    buffer_wbl2 sc1
    s_waitcnt vmcnt(0)
    s_mov_b64 exec, 1
    buffer_store_dword v2, off, s[56:59], s54 sc1
    s_mov_b64 exec, -1
    s_branch c3_pb
c4_slow:
    buffer_wbl2 sc1
    s_waitcnt vmcnt(0)
    s_mov_b64 exec, 1
    buffer_store_dword v4, off, s[56:59], s54 sc1
    s_mov_b64 exec, -1
    s_branch c4_pb
c3s_slow:
    buffer_wbl2 sc1
    s_waitcnt vmcnt(0)
    s_mov_b64 exec, 1
    buffer_store_dword v2, off, s[56:59], s54 sc1
    s_mov_b64 exec, -1
    s_branch c3s_pb
sequential_preLN__softmax_full_mha__dense_activation_relu__prompt_kernel_end:
    s_endpgm
.section .rodata,"a"
.p2align 6
.amdhsa_kernel sequential_preLN__softmax_full_mha__dense_activation_relu__prompt_kernel
  .amdhsa_next_free_vgpr 168
  .amdhsa_next_free_sgpr 64
  .amdhsa_accum_offset 168
  .amdhsa_group_segment_fixed_size 0
  .amdhsa_kernarg_size 72
  .amdhsa_user_sgpr_count 2
  .amdhsa_user_sgpr_kernarg_segment_ptr 1
  .amdhsa_system_sgpr_workgroup_id_x 1
.end_amdhsa_kernel
```
